```python
import torch

def _softmax(x, axis=-1):
    return torch.softmax(x, dim=axis)
def _gelu(x):
    return torch.nn.functional.gelu(x, approximate="tanh")
def _silu(x):
    return torch.nn.functional.silu(x)
def _sigmoid(x):
    return torch.sigmoid(x)
def _layernorm(x, axis=-1, eps=1e-5):
    m = x.mean(dim=axis, keepdim=True)
    v = x.var(dim=axis, keepdim=True, unbiased=False)
    return (x - m) / torch.sqrt(v + eps)
def _scatter_add(tgt, idx, src, axis=0):
    return tgt.clone().index_add_(axis, idx, src)
def _segment_sum(src, seg, n):
    out = torch.zeros((n,) + src.shape[1:], dtype=src.dtype)
    return out.index_add_(0, seg, src)
def _pad(x, pw):
    flat = tuple(v for pair in reversed(pw) for v in pair)
    return torch.nn.functional.pad(x, flat)

kernel_name = 'recurrent_scan__sliding_block__dense_activation_silu__prompt'

def setup_inputs():

    _w = (lambda a: (lambda t: t.to(torch.bfloat16) if t.is_floating_point() else t)(torch.as_tensor(a)))
    def _A_setup():
        B, S, D = 1, 2048, 448
        return {
            "x": _w((lambda *s: torch.randn(*s, dtype=torch.bfloat16) * 0.05)(B, S, D)),
            "wqkv": _w((lambda *s: torch.randn(*s, dtype=torch.bfloat16) * 0.2)(D, 3 * D)),
            "wo": _w((lambda *s: torch.randn(*s, dtype=torch.bfloat16) * 0.2)(D, D)),
        }
    _A_in = _A_setup()

    def _B_setup():
        B, S, D, F = 1, 2048, 448, 1792
        return {
            "x": _w((lambda *s: torch.randn(*s, dtype=torch.bfloat16) * 0.05)(B, S, D)),
            "w1": _w((lambda *s: torch.randn(*s, dtype=torch.bfloat16) * 3.2)(D, F) * (D ** -0.5)),
            "w2": _w((lambda *s: torch.randn(*s, dtype=torch.bfloat16) * 0.2)(F, D) * (F ** -0.5)),
        }
    _B_in = _B_setup()

    return {
        "A_x": _A_in["x"],
        "A_wqkv": _A_in["wqkv"],
        "A_wo": _A_in["wo"],
        "B_x": _B_in["x"],
        "B_w1": _B_in["w1"],
        "B_w2": _B_in["w2"],
    }

def reference(A_x, A_wqkv, A_wo, B_x, B_w1, B_w2):
    def _A_ref(x, wqkv, wo):
        B, S, D = x.shape
        H = 16; Dh = D // H; W = 256
        qkv = (lambda x, *d: x.permute(*d))((x @ wqkv).reshape(B, S, 3, H, Dh), 2, 0, 3, 1, 4)
        q, k, v = qkv[0], qkv[1], qkv[2]
        scores = torch.einsum("bhqd,bhkd->bhqk", q, k) * (Dh ** -0.5)
        idx = torch.arange(S)
        mask = (idx[:, None] - idx[None, :] >= 0) & (idx[:, None] - idx[None, :] < W)
        scores = torch.where(mask[None, None], scores, -1e9)
        p = _softmax(scores, axis=-1)
        o = torch.einsum("bhqk,bhkd->bhqd", p, v)
        return (lambda x, *d: x.permute(*d))(o, 0, 2, 1, 3).reshape(B, S, D) @ wo

    def _B_ref(x, w1, w2):
        h = torch.einsum("bsd,df->bsf", x, w1)
        h = _silu(h)
        out = torch.einsum("bsf,fd->bsd", h, w2)
        return out

    x = A_x
    xn = _layernorm(x, axis=-1)
    s = _A_ref(xn, A_wqkv, A_wo)
    g = _silu(_B_ref(xn, B_w1, B_w2))
    return x + s * g
```

```asm
; @launch grid=(256,1,1) block=(512,1,1) lds=163840
.amdgcn_target "amdgcn-amd-amdhsa--gfx950"
.text
.globl recurrent_scan__sliding_block__dense_activation_silu__prompt_kernel
.p2align 8
.type recurrent_scan__sliding_block__dense_activation_silu__prompt_kernel,@function
recurrent_scan__sliding_block__dense_activation_silu__prompt_kernel:
    s_cmp_ge_u32 s2, 256
    s_cbranch_scc1 L_end
    s_load_dwordx16 s[4:19], s[0:1], 0
    s_load_dwordx2 s[20:21], s[0:1], 64
    v_readfirstlane_b32 s44, v0
    s_getpc_b64 s[92:93]
L_pc0:
    s_lshr_b32 s45, s2, 3
    s_lshl_b32 s3, s45, 9
    s_add_u32 s3, s3, s44
    s_mul_i32 s3, s3, 5
    s_lshr_b32 s3, s3, 1
    s_min_u32 s3, s3, L_end-L_pc0-132
    s_load_dword s91, s[92:93], s3
    s_load_dword s90, s[92:93], s3 offset:128
    v_and_b32 v1, 63, v0
    v_lshlrev_b32 v2, 4, v1
    s_and_b32 s3, s2, 7
    s_lshr_b32 s44, s44, 6
    s_and_b32 s36, s44, 3
    s_and_b32 s40, s45, 1
    s_lshl1_add_u32 s40, s3, s40
    s_lshr_b32 s41, s45, 1
    s_sub_u32 s46, s45, 4
    s_cbranch_scc1 L_helper
    s_lshr_b32 s43, s46, 2
    s_and_b32 s46, s46, 3
    s_lshl2_add_u32 s42, s3, s46
    s_lshr_b32 s37, s3, 1
    s_lshl2_add_u32 s37, s37, s46
    s_and_b32 s38, s3, 1
    s_mul_i32 s38, s38, 7
    s_add_u32 s38, s38, s43
    s_lshl1_add_u32 s39, s46, s43
    s_sub_u32 s46, s39, 7
    s_min_u32 s39, s39, s46
    s_lshl_b32 s3, s37, 7
    s_lshl_b32 s46, s36, 5
    s_add_u32 s3, s3, s46
    v_lshrrev_b32 v9, 3, v1
    v_add_u32 v10, s3, v9
    v_mul_u32_u24 v240, 896, v10
    v_lshrrev_b32 v10, 4, v1
    v_and_b32 v11, 7, v1
    v_xor_b32 v12, v10, v11
    v_lshl_add_u32 v240, v12, 4, v240
    v_xor_b32 v241, 64, v240
    v_add_u32 v242, 12288, v240
    v_add_u32 v243, 18432, v241
    v_add_u32 v241, 6144, v241
    v_and_b32 v10, 1, v10
    v_lshlrev_b32 v10, 2, v10
    v_xor_b32 v10, v10, v11
    v_lshlrev_b32 v10, 4, v10
    s_lshl_b32 s46, s36, 4
    v_add_u32 v9, s46, v9
    s_mul_i32 s3, s38, 192
    s_and_b32 s3, s3, 0xffffff80
    s_add_u32 s3, s3, 1024
    v_mul_u32_u24 v244, 2688, v9
    v_add3_u32 v244, v244, v10, s3
    v_add_u32 v245, -896, v244
    v_add_u32 v246, 19456, v244
    v_add_u32 v247, 18560, v244
    s_lshl_b32 s48, s36, 12
    s_mov_b32 s26, 1835008
    s_mov_b32 s27, 0x20000
    s_mov_b32 s30, 1205248
    s_mov_b32 s31, 0x20000
    s_cmp_ge_u32 s44, 4
    s_cbranch_scc1 L_B
    s_mov_b32 m0, s48
    s_lshl_b32 s3, s39, 7
    s_mul_i32 s46, s39, 172032
    s_waitcnt lgkmcnt(0)
    s_mov_b32 s24, s4
    s_and_b32 s25, s5, 0xffff
    buffer_load_dwordx4 v240, s[24:27], s3 offen offset:0 lds
    buffer_load_dwordx4 v241, s[24:27], s3 offen offset:1024 lds
    buffer_load_dwordx4 v242, s[24:27], s3 offen offset:2048 lds
    buffer_load_dwordx4 v243, s[24:27], s3 offen offset:3072 lds
    s_add_u32 m0, s48, 16384
    s_sub_u32 s28, s6, 1024
    s_subb_u32 s29, s7, 0
    s_and_b32 s29, s29, 0xffff
    buffer_load_dwordx4 v244, s[28:31], s46 offen offset:0 lds
    buffer_load_dwordx4 v245, s[28:31], s46 offen offset:1024 lds
    buffer_load_dwordx4 v246, s[28:31], s46 offen offset:2048 lds
    buffer_load_dwordx4 v247, s[28:31], s46 offen offset:3072 lds
    s_mov_b32 s10, s44
    s_mov_b32 s11, s45
    s_and_b32 s21, s21, 0xffff
    s_mov_b32 s22, 20971520
    s_mov_b32 s23, 0x20000
    s_branch L_A
L_helper:
    s_mov_b32 s42, 0
    s_mov_b32 s59, 0
    s_waitcnt lgkmcnt(0)
    s_mov_b32 s10, s44
    s_mov_b32 s11, s45
    s_and_b32 s21, s21, 0xffff
    s_mov_b32 s22, 20971520
    s_mov_b32 s23, 0x20000
    s_mov_b32 s60, s18
    s_and_b32 s61, s19, 0xffff
    s_mov_b32 s62, 256
    s_mov_b32 s63, 0x20000
    s_mov_b32 s24, s12
    s_and_b32 s25, s13, 0xffff
    s_mov_b32 s26, 1605632
    s_mov_b32 s27, 0x20000
    v_mov_b32 v8, 0
    s_or_b32 s3, s2, s10
    s_cbranch_scc1 L_nononce
    s_memrealtime s[80:81]
    s_waitcnt lgkmcnt(0)
    s_or_b32 s81, s81, 0x80000000
    v_mov_b32 v62, s80
    v_mov_b32 v63, s81
    s_mov_b64 exec, 1
    buffer_store_dwordx2 v[62:63], v8, s[60:63], 0 offen sc1
    s_mov_b64 exec, -1
L_nononce:
    s_getpc_b64 s[28:29]
L_pc:
    s_sub_u32 s28, s28, L_pc-recurrent_scan__sliding_block__dense_activation_silu__prompt_kernel
    s_subb_u32 s29, s29, 0
    s_lshl3_add_u32 s46, s11, s10
    s_lshl_b32 s3, s46, 11
    v_and_b32 v4, 15, v1
    v_lshlrev_b32 v4, 7, v4
    v_add_u32 v4, s3, v4
    v_min_u32 v4, L_end-recurrent_scan__sliding_block__dense_activation_silu__prompt_kernel, v4
    global_load_dword v3, v4, s[28:29]
    s_waitcnt vmcnt(0)
    s_min_u32 s45, s2, 27
    s_mul_i32 s3, s10, 200704
    s_lshl_b32 s44, s45, 7
    s_add_u32 s3, s3, s44
    v_lshrrev_b32 v9, 3, v1
    v_mul_u32_u24 v9, 3584, v9
    v_and_b32 v10, 7, v1
    v_lshl_add_u32 v9, v10, 4, v9
    buffer_load_dwordx4 v[64:67], v9, s[24:27], s3 offen
    s_add_u32 s3, s3, 28672
    buffer_load_dwordx4 v[68:71], v9, s[24:27], s3 offen
    s_add_u32 s3, s3, 28672
    buffer_load_dwordx4 v[72:75], v9, s[24:27], s3 offen
    s_add_u32 s3, s3, 28672
    buffer_load_dwordx4 v[76:79], v9, s[24:27], s3 offen
    s_add_u32 s3, s3, 28672
    buffer_load_dwordx4 v[80:83], v9, s[24:27], s3 offen
    s_add_u32 s3, s3, 28672
    buffer_load_dwordx4 v[84:87], v9, s[24:27], s3 offen
    s_add_u32 s3, s3, 28672
    buffer_load_dwordx4 v[88:91], v9, s[24:27], s3 offen
    s_add_u32 s3, s3, 28672
    v_mov_b32 v7, 163712
    ds_write_b32 v7, v8 offset:16
    v_mov_b32 v5, 8
    ds_write_b32 v7, v5 offset:12
    s_waitcnt vmcnt(6)
    v_lshlrev_b32 v16, 16, v64
    v_and_b32 v17, 0xffff0000, v64
    v_lshlrev_b32 v18, 16, v65
    v_and_b32 v19, 0xffff0000, v65
    v_lshlrev_b32 v20, 16, v66
    v_and_b32 v21, 0xffff0000, v66
    v_lshlrev_b32 v22, 16, v67
    v_and_b32 v23, 0xffff0000, v67
    s_waitcnt vmcnt(5)
    v_lshlrev_b32 v24, 16, v68
    v_and_b32 v25, 0xffff0000, v68
    v_lshlrev_b32 v26, 16, v69
    v_and_b32 v27, 0xffff0000, v69
    v_lshlrev_b32 v28, 16, v70
    v_and_b32 v29, 0xffff0000, v70
    v_lshlrev_b32 v30, 16, v71
    v_and_b32 v31, 0xffff0000, v71
    v_pk_add_f32 v[16:17], v[16:17], v[24:25]
    v_pk_add_f32 v[18:19], v[18:19], v[26:27]
    v_pk_add_f32 v[20:21], v[20:21], v[28:29]
    v_pk_add_f32 v[22:23], v[22:23], v[30:31]
    s_waitcnt vmcnt(4)
    buffer_load_dwordx2 v[62:63], v8, s[60:63], 0 offen sc1
    v_lshlrev_b32 v24, 16, v72
    v_and_b32 v25, 0xffff0000, v72
    v_lshlrev_b32 v26, 16, v73
    v_and_b32 v27, 0xffff0000, v73
    v_lshlrev_b32 v28, 16, v74
    v_and_b32 v29, 0xffff0000, v74
    v_lshlrev_b32 v30, 16, v75
    v_and_b32 v31, 0xffff0000, v75
    v_pk_add_f32 v[16:17], v[16:17], v[24:25]
    v_pk_add_f32 v[18:19], v[18:19], v[26:27]
    v_pk_add_f32 v[20:21], v[20:21], v[28:29]
    v_pk_add_f32 v[22:23], v[22:23], v[30:31]
    s_waitcnt vmcnt(4)
    v_lshlrev_b32 v24, 16, v76
    v_and_b32 v25, 0xffff0000, v76
    v_lshlrev_b32 v26, 16, v77
    v_and_b32 v27, 0xffff0000, v77
    v_lshlrev_b32 v28, 16, v78
    v_and_b32 v29, 0xffff0000, v78
    v_lshlrev_b32 v30, 16, v79
    v_and_b32 v31, 0xffff0000, v79
    v_pk_add_f32 v[16:17], v[16:17], v[24:25]
    v_pk_add_f32 v[18:19], v[18:19], v[26:27]
    v_pk_add_f32 v[20:21], v[20:21], v[28:29]
    v_pk_add_f32 v[22:23], v[22:23], v[30:31]
    s_waitcnt vmcnt(3)
    v_lshlrev_b32 v24, 16, v80
    v_and_b32 v25, 0xffff0000, v80
    v_lshlrev_b32 v26, 16, v81
    v_and_b32 v27, 0xffff0000, v81
    v_lshlrev_b32 v28, 16, v82
    v_and_b32 v29, 0xffff0000, v82
    v_lshlrev_b32 v30, 16, v83
    v_and_b32 v31, 0xffff0000, v83
    v_pk_add_f32 v[16:17], v[16:17], v[24:25]
    v_pk_add_f32 v[18:19], v[18:19], v[26:27]
    v_pk_add_f32 v[20:21], v[20:21], v[28:29]
    v_pk_add_f32 v[22:23], v[22:23], v[30:31]
    s_waitcnt vmcnt(2)
    v_lshlrev_b32 v24, 16, v84
    v_and_b32 v25, 0xffff0000, v84
    v_lshlrev_b32 v26, 16, v85
    v_and_b32 v27, 0xffff0000, v85
    v_lshlrev_b32 v28, 16, v86
    v_and_b32 v29, 0xffff0000, v86
    v_lshlrev_b32 v30, 16, v87
    v_and_b32 v31, 0xffff0000, v87
    v_pk_add_f32 v[16:17], v[16:17], v[24:25]
    v_pk_add_f32 v[18:19], v[18:19], v[26:27]
    v_pk_add_f32 v[20:21], v[20:21], v[28:29]
    v_pk_add_f32 v[22:23], v[22:23], v[30:31]
    s_waitcnt vmcnt(1)
    v_lshlrev_b32 v24, 16, v88
    v_and_b32 v25, 0xffff0000, v88
    v_lshlrev_b32 v26, 16, v89
    v_and_b32 v27, 0xffff0000, v89
    v_lshlrev_b32 v28, 16, v90
    v_and_b32 v29, 0xffff0000, v90
    v_lshlrev_b32 v30, 16, v91
    v_and_b32 v31, 0xffff0000, v91
    v_pk_add_f32 v[16:17], v[16:17], v[24:25]
    v_pk_add_f32 v[18:19], v[18:19], v[26:27]
    v_pk_add_f32 v[20:21], v[20:21], v[28:29]
    v_pk_add_f32 v[22:23], v[22:23], v[30:31]
    s_lshl_b32 s3, s10, 11
    v_lshlrev_b32 v12, 5, v1
    v_add_u32 v12, s3, v12
    ds_write_b128 v12, v[16:19]
    ds_write_b128 v12, v[20:23] offset:16
    s_waitcnt lgkmcnt(0)
    s_barrier
    s_mov_b32 s47, 0
    s_waitcnt vmcnt(0)
    s_branch L_nz_19c
L_nz_19:
    buffer_load_dwordx2 v[62:63], v8, s[60:63], 0 offen sc1
    s_waitcnt vmcnt(0)
L_nz_19c:
    v_readfirstlane_b32 s81, v63
    v_readfirstlane_b32 s80, v62
    s_add_u32 s47, s47, 1
    s_cmp_lg_u32 s81, 0
    s_cbranch_scc1 L_nze_20
    s_sleep 2
    s_cmp_lt_u32 s47, 200000
    s_cbranch_scc1 L_nz_19
L_nze_20:
    s_cmp_lg_u32 s10, 0
    s_cbranch_scc1 L_hcs_done
    s_cmp_ge_u32 s2, 28
    s_cbranch_scc1 L_hcs_done
    s_setprio 3
    v_lshlrev_b32 v12, 2, v1
    ds_read2st64_b32 v[64:65], v12 offset0:0 offset1:1
    ds_read2st64_b32 v[66:67], v12 offset0:2 offset1:3
    ds_read2st64_b32 v[68:69], v12 offset0:4 offset1:5
    ds_read2st64_b32 v[70:71], v12 offset0:6 offset1:7
    ds_read2st64_b32 v[72:73], v12 offset0:8 offset1:9
    ds_read2st64_b32 v[74:75], v12 offset0:10 offset1:11
    ds_read2st64_b32 v[76:77], v12 offset0:12 offset1:13
    ds_read2st64_b32 v[78:79], v12 offset0:14 offset1:15
    s_waitcnt lgkmcnt(0)
    ds_read2st64_b32 v[80:81], v12 offset0:16 offset1:17
    ds_read2st64_b32 v[82:83], v12 offset0:18 offset1:19
    ds_read2st64_b32 v[84:85], v12 offset0:20 offset1:21
    ds_read2st64_b32 v[86:87], v12 offset0:22 offset1:23
    ds_read2st64_b32 v[88:89], v12 offset0:24 offset1:25
    ds_read2st64_b32 v[90:91], v12 offset0:26 offset1:27
    ds_read2st64_b32 v[92:93], v12 offset0:28 offset1:29
    ds_read2st64_b32 v[94:95], v12 offset0:30 offset1:31
    s_waitcnt lgkmcnt(0)
    ds_read2st64_b32 v[96:97], v12 offset0:32 offset1:33
    ds_read2st64_b32 v[98:99], v12 offset0:34 offset1:35
    ds_read2st64_b32 v[100:101], v12 offset0:36 offset1:37
    ds_read2st64_b32 v[102:103], v12 offset0:38 offset1:39
    ds_read2st64_b32 v[104:105], v12 offset0:40 offset1:41
    ds_read2st64_b32 v[106:107], v12 offset0:42 offset1:43
    ds_read2st64_b32 v[108:109], v12 offset0:44 offset1:45
    ds_read2st64_b32 v[110:111], v12 offset0:46 offset1:47
    s_waitcnt lgkmcnt(0)
    ds_read2st64_b32 v[112:113], v12 offset0:48 offset1:49
    ds_read2st64_b32 v[114:115], v12 offset0:50 offset1:51
    ds_read2st64_b32 v[116:117], v12 offset0:52 offset1:53
    ds_read2st64_b32 v[118:119], v12 offset0:54 offset1:55
    ds_read2st64_b32 v[120:121], v12 offset0:56 offset1:57
    ds_read2st64_b32 v[122:123], v12 offset0:58 offset1:59
    ds_read2st64_b32 v[124:125], v12 offset0:60 offset1:61
    ds_read2st64_b32 v[126:127], v12 offset0:62 offset1:63
    s_waitcnt lgkmcnt(0)
    v_pk_add_f32 v[64:65], v[64:65], v[96:97]
    v_pk_add_f32 v[66:67], v[66:67], v[98:99]
    v_pk_add_f32 v[68:69], v[68:69], v[100:101]
    v_pk_add_f32 v[70:71], v[70:71], v[102:103]
    v_pk_add_f32 v[72:73], v[72:73], v[104:105]
    v_pk_add_f32 v[74:75], v[74:75], v[106:107]
    v_pk_add_f32 v[76:77], v[76:77], v[108:109]
    v_pk_add_f32 v[78:79], v[78:79], v[110:111]
    v_pk_add_f32 v[80:81], v[80:81], v[112:113]
    v_pk_add_f32 v[82:83], v[82:83], v[114:115]
    v_pk_add_f32 v[84:85], v[84:85], v[116:117]
    v_pk_add_f32 v[86:87], v[86:87], v[118:119]
    v_pk_add_f32 v[88:89], v[88:89], v[120:121]
    v_pk_add_f32 v[90:91], v[90:91], v[122:123]
    v_pk_add_f32 v[92:93], v[92:93], v[124:125]
    v_pk_add_f32 v[94:95], v[94:95], v[126:127]
    v_pk_add_f32 v[64:65], v[64:65], v[80:81]
    v_pk_add_f32 v[66:67], v[66:67], v[82:83]
    v_pk_add_f32 v[68:69], v[68:69], v[84:85]
    v_pk_add_f32 v[70:71], v[70:71], v[86:87]
    v_pk_add_f32 v[72:73], v[72:73], v[88:89]
    v_pk_add_f32 v[74:75], v[74:75], v[90:91]
    v_pk_add_f32 v[76:77], v[76:77], v[92:93]
    v_pk_add_f32 v[78:79], v[78:79], v[94:95]
    v_pk_add_f32 v[64:65], v[64:65], v[72:73]
    v_pk_add_f32 v[66:67], v[66:67], v[74:75]
    v_pk_add_f32 v[68:69], v[68:69], v[76:77]
    v_pk_add_f32 v[70:71], v[70:71], v[78:79]
    v_pk_add_f32 v[64:65], v[64:65], v[68:69]
    v_pk_add_f32 v[66:67], v[66:67], v[70:71]
    v_pk_add_f32 v[64:65], v[64:65], v[66:67]
    v_add_f32 v64, v64, v65
    s_lshl_b32 s3, s2, 9
    s_add_u32 s48, s3, 17301504
    buffer_store_dword v64, v12, s[20:23], s48 offen sc1
    s_waitcnt vmcnt(0)
    v_lshlrev_b32 v11, 3, v1
    s_mov_b64 exec, 65535
    buffer_store_dwordx2 v[62:63], v11, s[20:23], s48 offen offset:256 sc1
    s_mov_b64 exec, -1
    s_setprio 0
L_hcs_done:
    s_barrier
    s_cmp_lt_u32 s10, 4
    s_cbranch_scc1 L_nohm
    s_mov_b32 s32, s14
    s_and_b32 s33, s15, 0xffff
    s_mov_b32 s34, 1605632
    s_mov_b32 s35, 0x20000
    s_mov_b32 s28, s8
    s_and_b32 s29, s9, 0xffff
    s_mov_b32 s30, 401408
    s_mov_b32 s31, 0x20000
    s_lshl2_add_u32 s46, s2, s36
    s_mul_i32 s3, s46, 12544
    v_min_u32 v4, 48, v1
    v_lshlrev_b32 v4, 7, v4
    buffer_load_dword v40, v4, s[32:35], s3 offen
    s_add_u32 s3, s3, 6272
    buffer_load_dword v41, v4, s[32:35], s3 offen
    s_mul_i32 s3, s46, 3200
    v_min_u32 v4, 24, v1
    v_lshlrev_b32 v4, 7, v4
    buffer_load_dword v42, v4, s[28:31], s3 offen
L_nohm:
    s_cmp_ge_u32 s10, 4
    s_cbranch_scc1 L_helperB
    s_lshl2_add_u32 s46, s11, s36
    s_endpgm
L_helperB:
    s_mul_i32 s3, s40, 7
    s_lshr_b32 s82, s3, 2
    s_and_b32 s83, s3, 3
    s_lshl2_add_u32 s84, s41, s36
    s_mul_i32 s3, s36, 3
    s_lshl2_add_u32 s3, s41, s3
    s_sub_u32 s85, s3, 8
    s_and_b32 s86, s36, 1
    s_lshr_b32 s87, s36, 1
    s_lshl1_add_u32 s88, s42, s87
    v_min_u32 v10, 13, v1
    v_lshrrev_b32 v26, 2, v10
    v_add_u32 v26, s85, v26
    v_max_i32 v26, 0, v26
    v_bfe_u32 v27, v10, 1, 1
    v_mul_u32_u24 v27, 28, v27
    v_add_u32 v27, 28, v27
    v_cmp_le_u32 vcc, 12, v10
    v_mov_b32 v28, s84
    s_nop 0
    v_cndmask_b32 v26, v26, v28, vcc
    v_cndmask_b32 v27, v27, v8, vcc
    v_and_b32 v28, 1, v10
    v_lshl_add_u32 v27, v28, 1, v27
    v_add_u32 v27, s82, v27
    v_lshrrev_b32 v27, 1, v27
    v_min_u32 v27, 41, v27
    v_mul_u32_u24 v28, 43, v27
    v_lshrrev_b32 v28, 7, v28
    v_mul_u32_u24 v29, 3, v28
    v_sub_u32 v29, v27, v29
    v_lshrrev_b32 v29, 1, v29
    v_mul_u32_u24 v26, 14, v26
    v_add_lshl_u32 v26, v26, v28, 1
    v_add_lshl_u32 v5, v26, v29, 7
    v_add_u32 v5, 18874368, v5
    v_lshrrev_b32 v26, 5, v1
    v_add_u32 v26, 2, v26
    v_add_u32 v27, 1073741824, v2
    v_cmp_gt_u32 vcc, s83, v26
    s_nop 1
    v_cndmask_b32 v3, v2, v27, vcc
    v_cmp_lt_u32 vcc, s83, v26
    s_nop 1
    v_cndmask_b32 v4, v2, v27, vcc
    s_mov_b32 s89, 0
    s_mov_b64 exec, 16383
    s_mov_b32 s47, 0
L_poll_21:
    buffer_load_dwordx2 v[28:29], v5, s[20:23], 0 offen offset:0 sc1
    s_add_u32 s47, s47, 1
    s_waitcnt vmcnt(0)
    v_cmp_ne_u64 vcc, s[80:81], v[28:29]
    s_nop 0
    s_cbranch_vccz L_polle_22
    s_sleep 24
    s_cmp_lt_u32 s47, 200000
    s_cbranch_scc1 L_poll_21
L_polle_22:
    s_mov_b64 exec, -1
    s_branch L_att
L_A:
    s_lshl_b32 s3, s38, 8
    v_mul_u32_u24 v30, 3584, v9
    v_add3_u32 v30, v30, v10, s3
    v_add_u32 v31, 27648, v30
    s_lshl_b32 s49, s36, 11
    s_add_u32 s50, s39, 0
    s_sub_u32 s46, s50, 7
    s_min_u32 s50, s50, s46
    s_add_u32 s51, s39, 1
    s_sub_u32 s46, s51, 7
    s_min_u32 s51, s51, s46
    s_add_u32 s52, s39, 2
    s_sub_u32 s46, s52, 7
    s_min_u32 s52, s52, s46
    s_add_u32 s53, s39, 3
    s_sub_u32 s46, s53, 7
    s_min_u32 s53, s53, s46
    s_add_u32 s54, s39, 4
    s_sub_u32 s46, s54, 7
    s_min_u32 s54, s54, s46
    s_add_u32 s55, s39, 5
    s_sub_u32 s46, s55, 7
    s_min_u32 s55, s55, s46
    s_add_u32 s56, s39, 6
    s_sub_u32 s46, s56, 7
    s_min_u32 s56, s56, s46
    s_mov_b32 s32, s12
    s_and_b32 s33, s13, 0xffff
    s_mov_b32 s34, 1605632
    s_mov_b32 s35, 0x20000
    v_mov_b32 v8, 0
    v_mov_b32 v7, 163712
    v_and_b32 v10, 31, v1
    v_lshlrev_b32 v12, 7, v10
    v_bfe_u32 v10, v1, 1, 3
    v_lshrrev_b32 v11, 5, v1
    v_xor_b32 v10, v10, v11
    v_lshl_add_u32 v12, v10, 4, v12
    v_add_u32 v12, s48, v12
    v_xor_b32 v13, 32, v12
    v_xor_b32 v14, 64, v12
    v_xor_b32 v15, 96, v12
    v_lshlrev_b32 v9, 4, v11
    v_add_u32 v9, 161792, v9
    v_lshrrev_b32 v24, 5, v1
    v_bfe_u32 v10, v1, 2, 2
    v_lshl_add_u32 v24, v24, 3, v10
    v_lshlrev_b32 v24, 7, v24
    v_bfe_u32 v10, v1, 3, 1
    v_lshl_add_u32 v24, v10, 6, v24
    v_bfe_u32 v10, v1, 4, 1
    v_lshl_add_u32 v24, v10, 5, v24
    v_and_b32 v10, 3, v1
    v_lshl_add_u32 v24, v10, 3, v24
    v_lshl_add_u32 v27, v11, 10, v24
    s_and_b32 s3, s38, 1
    s_add_u32 s44, s3, 0
    s_and_b32 s45, s44, 1
    s_lshl_b32 s45, s45, 6
    s_lshr_b32 s44, s44, 1
    s_lshl_b32 s44, s44, 10
    s_add_u32 s44, s44, 16384
    v_xor_b32 v16, s45, v27
    v_add_u32 v16, s44, v16
    s_add_u32 s44, s3, 1
    s_and_b32 s45, s44, 1
    s_lshl_b32 s45, s45, 6
    s_lshr_b32 s44, s44, 1
    s_lshl_b32 s44, s44, 10
    s_add_u32 s44, s44, 16384
    v_xor_b32 v17, s45, v27
    v_add_u32 v17, s44, v17
    v_and_b32 v10, 15, v1
    v_bfe_u32 v11, v1, 4, 1
    v_cmp_eq_u32 vcc, v10, v11
    v_mov_b32 v10, 0x3f803f80
    s_lshl2_add_u32 s3, s37, s36
    s_mul_i32 s57, s3, 84
    s_mul_i32 s44, s38, 6
    s_add_u32 s57, s57, s44
    s_add_u32 s57, s57, 0
    s_lshl_b32 s57, s57, 10
    s_mul_i32 s58, s3, 112
    s_lshl3_add_u32 s58, s38, s58
    s_lshl_b32 s58, s58, 10
    s_add_u32 s58, s58, 6293504
    s_mul_i32 s59, s3, 14
    s_add_u32 s59, s59, s38
    s_lshl_b32 s59, s59, 8
    s_add_u32 s59, s59, 18874368
    v_lshrrev_b32 v10, 3, v1
    v_mul_u32_u24 v3, 896, v10
    v_bfe_u32 v10, v1, 4, 1
    v_lshlrev_b32 v10, 2, v10
    v_and_b32 v11, 7, v1
    v_xor_b32 v10, v10, v11
    v_lshl_add_u32 v3, v10, 4, v3
    s_lshl_b32 s3, s43, 7
    v_add_u32 v3, s3, v3
    v_add_u32 v4, 6144, v3
    s_mul_i32 s3, s36, 14336
    s_mul_i32 s46, s43, 0
    s_and_b32 s44, s42, 3
    s_mul_i32 s44, s44, 0
    s_add_u32 s46, s46, s44
    s_sub_u32 s44, s46, 14336
    s_min_u32 s46, s46, s44
    s_add_u32 s44, s3, s46
    s_and_b32 s45, s44, 0xfffff000
    s_add_u32 s66, s44, s45
    s_add_u32 s46, s46, 1024
    s_cmp_eq_u32 s46, 14336
    s_cselect_b32 s46, 0, s46
    s_add_u32 s44, s3, s46
    s_and_b32 s45, s44, 0xfffff000
    s_add_u32 s67, s44, s45
    s_add_u32 s46, s46, 1024
    s_cmp_eq_u32 s46, 14336
    s_cselect_b32 s46, 0, s46
    s_add_u32 s44, s3, s46
    s_and_b32 s45, s44, 0xfffff000
    s_add_u32 s68, s44, s45
    s_add_u32 s46, s46, 1024
    s_cmp_eq_u32 s46, 14336
    s_cselect_b32 s46, 0, s46
    s_add_u32 s44, s3, s46
    s_and_b32 s45, s44, 0xfffff000
    s_add_u32 s69, s44, s45
    s_add_u32 s46, s46, 1024
    s_cmp_eq_u32 s46, 14336
    s_cselect_b32 s46, 0, s46
    s_add_u32 s44, s3, s46
    s_and_b32 s45, s44, 0xfffff000
    s_add_u32 s70, s44, s45
    s_add_u32 s46, s46, 1024
    s_cmp_eq_u32 s46, 14336
    s_cselect_b32 s46, 0, s46
    s_add_u32 s44, s3, s46
    s_and_b32 s45, s44, 0xfffff000
    s_add_u32 s71, s44, s45
    s_add_u32 s46, s46, 1024
    s_cmp_eq_u32 s46, 14336
    s_cselect_b32 s46, 0, s46
    s_add_u32 s44, s3, s46
    s_and_b32 s45, s44, 0xfffff000
    s_add_u32 s72, s44, s45
    s_add_u32 s46, s46, 1024
    s_cmp_eq_u32 s46, 14336
    s_cselect_b32 s46, 0, s46
    s_add_u32 s44, s3, s46
    s_and_b32 s45, s44, 0xfffff000
    s_add_u32 s73, s44, s45
    s_add_u32 s46, s46, 1024
    s_cmp_eq_u32 s46, 14336
    s_cselect_b32 s46, 0, s46
    s_add_u32 s44, s3, s46
    s_and_b32 s45, s44, 0xfffff000
    s_add_u32 s74, s44, s45
    s_add_u32 s46, s46, 1024
    s_cmp_eq_u32 s46, 14336
    s_cselect_b32 s46, 0, s46
    s_add_u32 s44, s3, s46
    s_and_b32 s45, s44, 0xfffff000
    s_add_u32 s75, s44, s45
    s_add_u32 s46, s46, 1024
    s_cmp_eq_u32 s46, 14336
    s_cselect_b32 s46, 0, s46
    s_add_u32 s44, s3, s46
    s_and_b32 s45, s44, 0xfffff000
    s_add_u32 s76, s44, s45
    s_add_u32 s46, s46, 1024
    s_cmp_eq_u32 s46, 14336
    s_cselect_b32 s46, 0, s46
    s_add_u32 s44, s3, s46
    s_and_b32 s45, s44, 0xfffff000
    s_add_u32 s77, s44, s45
    s_add_u32 s46, s46, 1024
    s_cmp_eq_u32 s46, 14336
    s_cselect_b32 s46, 0, s46
    s_add_u32 s44, s3, s46
    s_and_b32 s45, s44, 0xfffff000
    s_add_u32 s78, s44, s45
    s_add_u32 s46, s46, 1024
    s_cmp_eq_u32 s46, 14336
    s_cselect_b32 s46, 0, s46
    s_add_u32 s44, s3, s46
    s_and_b32 s45, s44, 0xfffff000
    s_add_u32 s79, s44, s45
    s_mov_b32 s60, s18
    s_and_b32 s61, s19, 0xffff
    s_mov_b32 s62, 256
    s_mov_b32 s63, 0x20000
    v_and_b32 v10, 7, v1
    v_lshl_add_u32 v10, v10, 2, v7
    ds_write_b32 v10, v8
    s_waitcnt vmcnt(0) lgkmcnt(0)
    s_barrier
    ds_read_b128 v[128:131], v12 offset:0
    ds_read_b64_tr_b16 v[32:33], v16 offset:0
    ds_read_b64_tr_b16 v[34:35], v16 offset:512
    ds_read_b64_tr_b16 v[36:37], v17 offset:0
    ds_read_b64_tr_b16 v[38:39], v17 offset:512
    ds_read_b128 v[132:135], v13 offset:0
    ds_read_b64_tr_b16 v[40:41], v16 offset:4096
    ds_read_b64_tr_b16 v[42:43], v16 offset:4608
    ds_read_b64_tr_b16 v[44:45], v17 offset:4096
    ds_read_b64_tr_b16 v[46:47], v17 offset:4608
    ds_read_b128 v[136:139], v14 offset:0
    ds_read_b128 v[140:143], v15 offset:0
    s_waitcnt lgkmcnt(7)
    v_mfma_f32_32x32x16_bf16 v[64:79], v[32:35], v[128:131], 0
    ds_read_b64_tr_b16 v[48:49], v16 offset:8192
    ds_read_b64_tr_b16 v[50:51], v16 offset:8704
    ds_read_b64_tr_b16 v[52:53], v17 offset:8192
    ds_read_b64_tr_b16 v[54:55], v17 offset:8704
    v_mfma_f32_32x32x16_bf16 v[80:95], v[36:39], v[128:131], 0
    s_add_u32 m0, s48, 65536
    s_lshl_b32 s3, s52, 7
    buffer_load_dwordx4 v240, s[24:27], s3 offen offset:0 lds
    buffer_load_dwordx4 v241, s[24:27], s3 offen offset:1024 lds
    s_waitcnt lgkmcnt(6)
    v_mfma_f32_32x32x16_bf16 v[64:79], v[40:43], v[132:135], v[64:79]
    ds_read_b64_tr_b16 v[32:33], v16 offset:12288
    ds_read_b64_tr_b16 v[34:35], v16 offset:12800
    ds_read_b64_tr_b16 v[36:37], v17 offset:12288
    v_mfma_f32_32x32x16_bf16 v[80:95], v[44:47], v[132:135], v[80:95]
    ds_read_b64_tr_b16 v[38:39], v17 offset:12800
    buffer_load_dwordx4 v242, s[24:27], s3 offen offset:2048 lds
    buffer_load_dwordx4 v243, s[24:27], s3 offen offset:3072 lds
    s_waitcnt lgkmcnt(0)
    s_barrier
    v_mfma_f32_32x32x16_bf16 v[64:79], v[48:51], v[136:139], v[64:79]
    ds_read_b128 v[144:147], v12 offset:32768
    ds_read_b128 v[148:151], v13 offset:32768
    ds_read_b64_tr_b16 v[40:41], v16 offset:32768
    ds_read_b64_tr_b16 v[42:43], v16 offset:33280
    ds_read_b64_tr_b16 v[44:45], v17 offset:32768
    v_mfma_f32_32x32x16_bf16 v[80:95], v[52:55], v[136:139], v[80:95]
    ds_read_b64_tr_b16 v[46:47], v17 offset:33280
    s_add_u32 m0, s48, 0
    s_lshl_b32 s3, s53, 7
    buffer_load_dwordx4 v240, s[24:27], s3 offen offset:0 lds
    buffer_load_dwordx4 v241, s[24:27], s3 offen offset:1024 lds
    v_mfma_f32_32x32x16_bf16 v[64:79], v[32:35], v[140:143], v[64:79]
    ds_read_b128 v[152:155], v14 offset:32768
    ds_read_b128 v[156:159], v15 offset:32768
    ds_read_b64_tr_b16 v[48:49], v16 offset:36864
    ds_read_b64_tr_b16 v[50:51], v16 offset:37376
    v_mfma_f32_32x32x16_bf16 v[80:95], v[36:39], v[140:143], v[80:95]
    ds_read_b64_tr_b16 v[52:53], v17 offset:36864
    ds_read_b64_tr_b16 v[54:55], v17 offset:37376
    buffer_load_dwordx4 v242, s[24:27], s3 offen offset:2048 lds
    s_waitcnt lgkmcnt(6)
    v_mfma_f32_32x32x16_bf16 v[64:79], v[40:43], v[144:147], v[64:79]
    ds_read_b64_tr_b16 v[32:33], v16 offset:40960
    ds_read_b64_tr_b16 v[34:35], v16 offset:41472
    ds_read_b64_tr_b16 v[36:37], v17 offset:40960
    ds_read_b64_tr_b16 v[38:39], v17 offset:41472
    v_mfma_f32_32x32x16_bf16 v[80:95], v[44:47], v[144:147], v[80:95]
    buffer_load_dwordx4 v243, s[24:27], s3 offen offset:3072 lds
    s_add_u32 m0, s49, 98304
    s_mul_i32 s3, s50, 229376
    buffer_load_dwordx4 v30, s[32:35], s3 offen lds
    s_waitcnt lgkmcnt(4)
    v_mfma_f32_32x32x16_bf16 v[64:79], v[48:51], v[148:151], v[64:79]
    ds_read_b64_tr_b16 v[40:41], v16 offset:45056
    ds_read_b64_tr_b16 v[42:43], v16 offset:45568
    ds_read_b64_tr_b16 v[44:45], v17 offset:45056
    v_mfma_f32_32x32x16_bf16 v[80:95], v[52:55], v[148:151], v[80:95]
    ds_read_b64_tr_b16 v[46:47], v17 offset:45568
    buffer_load_dwordx4 v31, s[32:35], s3 offen offset:1024 lds
    s_waitcnt vmcnt(6) lgkmcnt(0)
    s_barrier
    v_add_u32 v12, 65536, v12
    v_add_u32 v13, 65536, v13
    v_add_u32 v14, 65536, v14
    v_add_u32 v15, 65536, v15
    v_add_u32 v16, 65536, v16
    v_add_u32 v17, 65536, v17
    v_mfma_f32_32x32x16_bf16 v[64:79], v[32:35], v[152:155], v[64:79]
    ds_read_b128 v[160:163], v12 offset:0
    ds_read_b128 v[164:167], v13 offset:0
    ds_read_b64_tr_b16 v[48:49], v16 offset:0
    ds_read_b64_tr_b16 v[50:51], v16 offset:512
    ds_read_b64_tr_b16 v[52:53], v17 offset:0
    v_mfma_f32_32x32x16_bf16 v[80:95], v[36:39], v[152:155], v[80:95]
    ds_read_b64_tr_b16 v[54:55], v17 offset:512
    s_add_u32 m0, s48, 32768
    s_lshl_b32 s3, s54, 7
    buffer_load_dwordx4 v240, s[24:27], s3 offen offset:0 lds
    buffer_load_dwordx4 v241, s[24:27], s3 offen offset:1024 lds
    v_mfma_f32_32x32x16_bf16 v[64:79], v[40:43], v[156:159], v[64:79]
    ds_read_b128 v[168:171], v14 offset:0
    ds_read_b128 v[172:175], v15 offset:0
    ds_read_b64_tr_b16 v[32:33], v16 offset:4096
    ds_read_b64_tr_b16 v[34:35], v16 offset:4608
    v_mfma_f32_32x32x16_bf16 v[80:95], v[44:47], v[156:159], v[80:95]
    ds_read_b64_tr_b16 v[36:37], v17 offset:4096
    ds_read_b64_tr_b16 v[38:39], v17 offset:4608
    buffer_load_dwordx4 v242, s[24:27], s3 offen offset:2048 lds
    s_waitcnt lgkmcnt(6)
    v_mfma_f32_32x32x16_bf16 v[64:79], v[48:51], v[160:163], v[64:79]
    ds_read_b64_tr_b16 v[40:41], v16 offset:8192
    ds_read_b64_tr_b16 v[42:43], v16 offset:8704
    ds_read_b64_tr_b16 v[44:45], v17 offset:8192
    ds_read_b64_tr_b16 v[46:47], v17 offset:8704
    v_mfma_f32_32x32x16_bf16 v[80:95], v[52:55], v[160:163], v[80:95]
    buffer_load_dwordx4 v243, s[24:27], s3 offen offset:3072 lds
    s_add_u32 m0, s49, 106496
    s_mul_i32 s3, s51, 229376
    buffer_load_dwordx4 v30, s[32:35], s3 offen lds
    s_waitcnt lgkmcnt(4)
    v_mfma_f32_32x32x16_bf16 v[64:79], v[32:35], v[164:167], v[64:79]
    ds_read_b64_tr_b16 v[48:49], v16 offset:12288
    ds_read_b64_tr_b16 v[50:51], v16 offset:12800
    ds_read_b64_tr_b16 v[52:53], v17 offset:12288
    v_mfma_f32_32x32x16_bf16 v[80:95], v[36:39], v[164:167], v[80:95]
    ds_read_b64_tr_b16 v[54:55], v17 offset:12800
    buffer_load_dwordx4 v31, s[32:35], s3 offen offset:1024 lds
    s_waitcnt vmcnt(8) lgkmcnt(0)
    s_barrier
    v_subrev_u32 v12, 65536, v12
    v_subrev_u32 v13, 65536, v13
    v_subrev_u32 v14, 65536, v14
    v_subrev_u32 v15, 65536, v15
    v_subrev_u32 v16, 65536, v16
    v_subrev_u32 v17, 65536, v17
    v_mfma_f32_32x32x16_bf16 v[64:79], v[40:43], v[168:171], v[64:79]
    ds_read_b128 v[176:179], v12 offset:0
    ds_read_b128 v[180:183], v13 offset:0
    ds_read_b64_tr_b16 v[32:33], v16 offset:0
    ds_read_b64_tr_b16 v[34:35], v16 offset:512
    ds_read_b64_tr_b16 v[36:37], v17 offset:0
    v_mfma_f32_32x32x16_bf16 v[80:95], v[44:47], v[168:171], v[80:95]
    ds_read_b64_tr_b16 v[38:39], v17 offset:512
    s_add_u32 m0, s48, 65536
    s_lshl_b32 s3, s55, 7
    buffer_load_dwordx4 v240, s[24:27], s3 offen offset:0 lds
    buffer_load_dwordx4 v241, s[24:27], s3 offen offset:1024 lds
    v_mfma_f32_32x32x16_bf16 v[64:79], v[48:51], v[172:175], v[64:79]
    ds_read_b128 v[184:187], v14 offset:0
    ds_read_b128 v[188:191], v15 offset:0
    ds_read_b64_tr_b16 v[40:41], v16 offset:4096
    ds_read_b64_tr_b16 v[42:43], v16 offset:4608
    v_mfma_f32_32x32x16_bf16 v[80:95], v[52:55], v[172:175], v[80:95]
    ds_read_b64_tr_b16 v[44:45], v17 offset:4096
    ds_read_b64_tr_b16 v[46:47], v17 offset:4608
    buffer_load_dwordx4 v242, s[24:27], s3 offen offset:2048 lds
    s_waitcnt lgkmcnt(6)
    v_mfma_f32_32x32x16_bf16 v[64:79], v[32:35], v[176:179], v[64:79]
    ds_read_b64_tr_b16 v[48:49], v16 offset:8192
    ds_read_b64_tr_b16 v[50:51], v16 offset:8704
    ds_read_b64_tr_b16 v[52:53], v17 offset:8192
    ds_read_b64_tr_b16 v[54:55], v17 offset:8704
    v_mfma_f32_32x32x16_bf16 v[80:95], v[36:39], v[176:179], v[80:95]
    buffer_load_dwordx4 v243, s[24:27], s3 offen offset:3072 lds
    s_add_u32 m0, s49, 114688
    s_mul_i32 s3, s52, 229376
    buffer_load_dwordx4 v30, s[32:35], s3 offen lds
    s_waitcnt lgkmcnt(4)
    v_mfma_f32_32x32x16_bf16 v[64:79], v[40:43], v[180:183], v[64:79]
    ds_read_b64_tr_b16 v[32:33], v16 offset:12288
    ds_read_b64_tr_b16 v[34:35], v16 offset:12800
    ds_read_b64_tr_b16 v[36:37], v17 offset:12288
    v_mfma_f32_32x32x16_bf16 v[80:95], v[44:47], v[180:183], v[80:95]
    ds_read_b64_tr_b16 v[38:39], v17 offset:12800
    buffer_load_dwordx4 v31, s[32:35], s3 offen offset:1024 lds
    s_waitcnt vmcnt(8) lgkmcnt(0)
    s_barrier
    v_mfma_f32_32x32x16_bf16 v[64:79], v[48:51], v[184:187], v[64:79]
    ds_read_b128 v[192:195], v12 offset:32768
    ds_read_b128 v[196:199], v13 offset:32768
    ds_read_b64_tr_b16 v[40:41], v16 offset:32768
    ds_read_b64_tr_b16 v[42:43], v16 offset:33280
    ds_read_b64_tr_b16 v[44:45], v17 offset:32768
    v_mfma_f32_32x32x16_bf16 v[80:95], v[52:55], v[184:187], v[80:95]
    ds_read_b64_tr_b16 v[46:47], v17 offset:33280
    s_add_u32 m0, s48, 0
    s_lshl_b32 s3, s56, 7
    buffer_load_dwordx4 v240, s[24:27], s3 offen offset:0 lds
    buffer_load_dwordx4 v241, s[24:27], s3 offen offset:1024 lds
    v_mfma_f32_32x32x16_bf16 v[64:79], v[32:35], v[188:191], v[64:79]
    ds_read_b128 v[200:203], v14 offset:32768
    ds_read_b128 v[204:207], v15 offset:32768
    ds_read_b64_tr_b16 v[48:49], v16 offset:36864
    ds_read_b64_tr_b16 v[50:51], v16 offset:37376
    v_mfma_f32_32x32x16_bf16 v[80:95], v[36:39], v[188:191], v[80:95]
    ds_read_b64_tr_b16 v[52:53], v17 offset:36864
    ds_read_b64_tr_b16 v[54:55], v17 offset:37376
    buffer_load_dwordx4 v242, s[24:27], s3 offen offset:2048 lds
    s_waitcnt lgkmcnt(6)
    v_mfma_f32_32x32x16_bf16 v[64:79], v[40:43], v[192:195], v[64:79]
    ds_read_b64_tr_b16 v[32:33], v16 offset:40960
    ds_read_b64_tr_b16 v[34:35], v16 offset:41472
    ds_read_b64_tr_b16 v[36:37], v17 offset:40960
    ds_read_b64_tr_b16 v[38:39], v17 offset:41472
    v_mfma_f32_32x32x16_bf16 v[80:95], v[44:47], v[192:195], v[80:95]
    buffer_load_dwordx4 v243, s[24:27], s3 offen offset:3072 lds
    s_add_u32 m0, s49, 122880
    s_mul_i32 s3, s53, 229376
    buffer_load_dwordx4 v30, s[32:35], s3 offen lds
    s_waitcnt lgkmcnt(4)
    v_mfma_f32_32x32x16_bf16 v[64:79], v[48:51], v[196:199], v[64:79]
    ds_read_b64_tr_b16 v[40:41], v16 offset:45056
    ds_read_b64_tr_b16 v[42:43], v16 offset:45568
    ds_read_b64_tr_b16 v[44:45], v17 offset:45056
    v_mfma_f32_32x32x16_bf16 v[80:95], v[52:55], v[196:199], v[80:95]
    ds_read_b64_tr_b16 v[46:47], v17 offset:45568
    buffer_load_dwordx4 v31, s[32:35], s3 offen offset:1024 lds
    s_waitcnt vmcnt(8) lgkmcnt(0)
    s_barrier
    v_add_u32 v12, 65536, v12
    v_add_u32 v13, 65536, v13
    v_add_u32 v14, 65536, v14
    v_add_u32 v15, 65536, v15
    v_add_u32 v16, 65536, v16
    v_add_u32 v17, 65536, v17
    v_mfma_f32_32x32x16_bf16 v[64:79], v[32:35], v[200:203], v[64:79]
    ds_read_b128 v[208:211], v12 offset:0
    ds_read_b128 v[212:215], v13 offset:0
    ds_read_b64_tr_b16 v[48:49], v16 offset:0
    ds_read_b64_tr_b16 v[50:51], v16 offset:512
    ds_read_b64_tr_b16 v[52:53], v17 offset:0
    v_mfma_f32_32x32x16_bf16 v[80:95], v[36:39], v[200:203], v[80:95]
    ds_read_b64_tr_b16 v[54:55], v17 offset:512
    s_add_u32 m0, s49, 131072
    s_mul_i32 s3, s54, 229376
    buffer_load_dwordx4 v30, s[32:35], s3 offen lds
    buffer_load_dwordx4 v31, s[32:35], s3 offen offset:1024 lds
    v_mfma_f32_32x32x16_bf16 v[64:79], v[40:43], v[204:207], v[64:79]
    ds_read_b128 v[216:219], v14 offset:0
    ds_read_b128 v[220:223], v15 offset:0
    ds_read_b64_tr_b16 v[32:33], v16 offset:4096
    ds_read_b64_tr_b16 v[34:35], v16 offset:4608
    ds_read_b64_tr_b16 v[36:37], v17 offset:4096
    v_mfma_f32_32x32x16_bf16 v[80:95], v[44:47], v[204:207], v[80:95]
    ds_read_b64_tr_b16 v[38:39], v17 offset:4608
    s_add_u32 m0, s49, 147456
    s_mul_i32 s3, s56, 229376
    buffer_load_dwordx4 v30, s[32:35], s3 offen lds
    s_waitcnt lgkmcnt(6)
    v_mfma_f32_32x32x16_bf16 v[64:79], v[48:51], v[208:211], v[64:79]
    ds_read_b64_tr_b16 v[40:41], v16 offset:8192
    ds_read_b64_tr_b16 v[42:43], v16 offset:8704
    ds_read_b64_tr_b16 v[44:45], v17 offset:8192
    ds_read_b64_tr_b16 v[46:47], v17 offset:8704
    buffer_load_dwordx4 v31, s[32:35], s3 offen offset:1024 lds
    v_mfma_f32_32x32x16_bf16 v[80:95], v[52:55], v[208:211], v[80:95]
    s_add_u32 m0, s49, 32768
    s_mul_i32 s3, s50, 229376
    s_add_u32 s3, s3, 128
    buffer_load_dwordx4 v30, s[32:35], s3 offen lds
    s_waitcnt lgkmcnt(4)
    v_mfma_f32_32x32x16_bf16 v[64:79], v[32:35], v[212:215], v[64:79]
    ds_read_b64_tr_b16 v[48:49], v16 offset:12288
    ds_read_b64_tr_b16 v[50:51], v16 offset:12800
    ds_read_b64_tr_b16 v[52:53], v17 offset:12288
    v_mfma_f32_32x32x16_bf16 v[80:95], v[36:39], v[212:215], v[80:95]
    ds_read_b64_tr_b16 v[54:55], v17 offset:12800
    buffer_load_dwordx4 v31, s[32:35], s3 offen offset:1024 lds
    s_waitcnt vmcnt(8) lgkmcnt(0)
    s_barrier
    v_subrev_u32 v12, 65536, v12
    v_subrev_u32 v13, 65536, v13
    v_subrev_u32 v14, 65536, v14
    v_subrev_u32 v15, 65536, v15
    v_subrev_u32 v16, 65536, v16
    v_subrev_u32 v17, 65536, v17
    v_mfma_f32_32x32x16_bf16 v[64:79], v[40:43], v[216:219], v[64:79]
    ds_read_b128 v[224:227], v12 offset:0
    ds_read_b128 v[228:231], v13 offset:0
    ds_read_b64_tr_b16 v[32:33], v16 offset:0
    ds_read_b64_tr_b16 v[34:35], v16 offset:512
    ds_read_b64_tr_b16 v[36:37], v17 offset:0
    ds_read_b64_tr_b16 v[38:39], v17 offset:512
    v_mfma_f32_32x32x16_bf16 v[80:95], v[44:47], v[216:219], v[80:95]
    s_add_u32 m0, s49, 49152
    s_mul_i32 s3, s52, 229376
    s_add_u32 s3, s3, 128
    buffer_load_dwordx4 v30, s[32:35], s3 offen lds
    buffer_load_dwordx4 v31, s[32:35], s3 offen offset:1024 lds
    v_mfma_f32_32x32x16_bf16 v[64:79], v[48:51], v[220:223], v[64:79]
    ds_read_b128 v[232:235], v14 offset:0
    ds_read_b128 v[236:239], v15 offset:0
    ds_read_b64_tr_b16 v[40:41], v16 offset:4096
    ds_read_b64_tr_b16 v[42:43], v16 offset:4608
    ds_read_b64_tr_b16 v[44:45], v17 offset:4096
    ds_read_b64_tr_b16 v[46:47], v17 offset:4608
    v_mfma_f32_32x32x16_bf16 v[80:95], v[52:55], v[220:223], v[80:95]
    s_add_u32 m0, s49, 65536
    s_mul_i32 s3, s54, 229376
    s_add_u32 s3, s3, 128
    buffer_load_dwordx4 v30, s[32:35], s3 offen lds
    buffer_load_dwordx4 v31, s[32:35], s3 offen offset:1024 lds
    s_waitcnt lgkmcnt(6)
    v_mfma_f32_32x32x16_bf16 v[64:79], v[32:35], v[224:227], v[64:79]
    ds_read_b64_tr_b16 v[48:49], v16 offset:8192
    ds_read_b64_tr_b16 v[50:51], v16 offset:8704
    ds_read_b64_tr_b16 v[52:53], v17 offset:8192
    ds_read_b64_tr_b16 v[54:55], v17 offset:8704
    s_add_u32 m0, s49, 73728
    v_mfma_f32_32x32x16_bf16 v[80:95], v[36:39], v[224:227], v[80:95]
    s_mul_i32 s3, s55, 229376
    s_add_u32 s3, s3, 128
    buffer_load_dwordx4 v30, s[32:35], s3 offen lds
    buffer_load_dwordx4 v31, s[32:35], s3 offen offset:1024 lds
    buffer_load_dwordx2 v[62:63], v8, s[60:63], 0 offen sc1
    s_lshl_b32 s44, s38, 10
    s_add_u32 s44, s44, 17301504
    v_and_b32 v25, 1, v1
    v_lshlrev_b32 v25, 9, v25
    buffer_load_dwordx2 v[28:29], v25, s[20:23], s44 offen offset:256 sc1
    s_waitcnt lgkmcnt(4)
    v_mfma_f32_32x32x16_bf16 v[64:79], v[40:43], v[228:231], v[64:79]
    ds_read_b64_tr_b16 v[32:33], v16 offset:12288
    ds_read_b64_tr_b16 v[34:35], v16 offset:12800
    ds_read_b64_tr_b16 v[36:37], v17 offset:12288
    ds_read_b64_tr_b16 v[38:39], v17 offset:12800
    s_add_u32 m0, s49, 81920
    v_mfma_f32_32x32x16_bf16 v[80:95], v[44:47], v[228:231], v[80:95]
    s_mul_i32 s3, s56, 229376
    s_add_u32 s3, s3, 128
    buffer_load_dwordx4 v30, s[32:35], s3 offen lds
    buffer_load_dwordx4 v31, s[32:35], s3 offen offset:1024 lds
    s_waitcnt lgkmcnt(4)
    v_mfma_f32_32x32x16_bf16 v[64:79], v[48:51], v[232:235], v[64:79]
    v_mfma_f32_32x32x16_bf16 v[80:95], v[52:55], v[232:235], v[80:95]
    s_lshl3_add_u32 s3, s42, s10
    s_lshl_b32 s3, s3, 3
    v_lshrrev_b32 v10, 3, v1
    v_add_u32 v10, s3, v10
    v_mul_u32_u24 v61, 896, v10
    v_and_b32 v10, 7, v1
    v_lshl_add_u32 v61, v10, 4, v61
    s_lshl_b32 s3, s43, 7
    v_add_u32 v61, s3, v61
    global_load_dwordx4 v[56:59], v61, s[4:5]
    s_waitcnt lgkmcnt(0)
    v_mfma_f32_32x32x16_bf16 v[64:79], v[32:35], v[236:239], v[64:79]
    v_mfma_f32_32x32x16_bf16 v[80:95], v[36:39], v[236:239], v[80:95]
    s_waitcnt vmcnt(13)
    s_setprio 3
    s_waitcnt lgkmcnt(0)
    s_barrier
    v_and_b32 v21, 31, v1
    s_lshl_b32 s44, s36, 8
    s_add_u32 s44, s44, 155648
    v_lshl_add_u32 v21, v21, 3, s44
    ds_read_b64 v[18:19], v21 offset:1024
    ds_read_b128 v[96:99], v9 offset:0
    ds_read_b128 v[100:103], v9 offset:32
    ds_read_b128 v[104:107], v9 offset:64
    ds_read_b128 v[108:111], v9 offset:96
    ds_read_b128 v[112:115], v9 offset:128
    ds_read_b128 v[116:119], v9 offset:160
    ds_read_b128 v[120:123], v9 offset:192
    ds_read_b128 v[124:127], v9 offset:224
    s_waitcnt lgkmcnt(8)
    v_mul_f32 v18, 0xbb124925, v18
    v_mul_f32 v19, 0x3b124925, v19
    v_fma_f32 v19, -v18, v18, v19
    v_max_f32 v19, 0, v19
    v_add_f32 v19, 0x3727c5ac, v19
    v_rsq_f32 v20, v19
    v_sqrt_f32 v23, v19
    v_mov_b32 v19, v18
    v_mul_f32 v22, 0xbfb8aa3b, v20
    s_mul_i32 s3, s38, 3
    s_cmp_lt_u32 s3, 14
    s_cselect_b32 s3, 0x3e8b97f6, 1.0
    v_mul_f32 v26, s3, v20
    s_waitcnt lgkmcnt(4)
    v_mov_b32 v27, v26
    v_pk_fma_f32 v[64:65], v[96:97], v[18:19], v[64:65]
    v_pk_fma_f32 v[66:67], v[98:99], v[18:19], v[66:67]
    v_pk_fma_f32 v[68:69], v[100:101], v[18:19], v[68:69]
    v_pk_fma_f32 v[70:71], v[102:103], v[18:19], v[70:71]
    v_pk_fma_f32 v[72:73], v[104:105], v[18:19], v[72:73]
    v_pk_fma_f32 v[74:75], v[106:107], v[18:19], v[74:75]
    v_pk_fma_f32 v[76:77], v[108:109], v[18:19], v[76:77]
    v_pk_fma_f32 v[78:79], v[110:111], v[18:19], v[78:79]
    v_pk_mul_f32 v[64:65], v[64:65], v[26:27]
    v_pk_mul_f32 v[66:67], v[66:67], v[26:27]
    v_pk_mul_f32 v[68:69], v[68:69], v[26:27]
    v_pk_mul_f32 v[70:71], v[70:71], v[26:27]
    v_pk_mul_f32 v[72:73], v[72:73], v[26:27]
    v_pk_mul_f32 v[74:75], v[74:75], v[26:27]
    v_pk_mul_f32 v[76:77], v[76:77], v[26:27]
    v_pk_mul_f32 v[78:79], v[78:79], v[26:27]
    v_cvt_pk_bf16_f32 v64, v64, v65
    v_cvt_pk_bf16_f32 v65, v66, v67
    v_cvt_pk_bf16_f32 v66, v68, v69
    v_cvt_pk_bf16_f32 v67, v70, v71
    buffer_store_dwordx4 v[64:67], v2, s[20:23], s57 offen offset:0 sc1
    v_cvt_pk_bf16_f32 v68, v72, v73
    v_cvt_pk_bf16_f32 v69, v74, v75
    v_cvt_pk_bf16_f32 v70, v76, v77
    v_cvt_pk_bf16_f32 v71, v78, v79
    buffer_store_dwordx4 v[68:71], v2, s[20:23], s57 offen offset:1024 sc1
    s_mul_i32 s3, s38, 3
    s_cmp_lt_u32 s3, 13
    s_cselect_b32 s3, 0x3e8b97f6, 1.0
    v_mul_f32 v26, s3, v20
    s_waitcnt lgkmcnt(0)
    v_mov_b32 v27, v26
    v_pk_fma_f32 v[80:81], v[112:113], v[18:19], v[80:81]
    v_pk_fma_f32 v[82:83], v[114:115], v[18:19], v[82:83]
    v_pk_fma_f32 v[84:85], v[116:117], v[18:19], v[84:85]
    v_pk_fma_f32 v[86:87], v[118:119], v[18:19], v[86:87]
    v_pk_fma_f32 v[88:89], v[120:121], v[18:19], v[88:89]
    v_pk_fma_f32 v[90:91], v[122:123], v[18:19], v[90:91]
    v_pk_fma_f32 v[92:93], v[124:125], v[18:19], v[92:93]
    v_pk_fma_f32 v[94:95], v[126:127], v[18:19], v[94:95]
    v_pk_mul_f32 v[80:81], v[80:81], v[26:27]
    v_pk_mul_f32 v[82:83], v[82:83], v[26:27]
    v_pk_mul_f32 v[84:85], v[84:85], v[26:27]
    v_pk_mul_f32 v[86:87], v[86:87], v[26:27]
    v_pk_mul_f32 v[88:89], v[88:89], v[26:27]
    v_pk_mul_f32 v[90:91], v[90:91], v[26:27]
    v_pk_mul_f32 v[92:93], v[92:93], v[26:27]
    v_pk_mul_f32 v[94:95], v[94:95], v[26:27]
    v_cvt_pk_bf16_f32 v80, v80, v81
    v_cvt_pk_bf16_f32 v81, v82, v83
    v_cvt_pk_bf16_f32 v82, v84, v85
    v_cvt_pk_bf16_f32 v83, v86, v87
    buffer_store_dwordx4 v[80:83], v2, s[20:23], s57 offen offset:2048 sc1
    v_cvt_pk_bf16_f32 v84, v88, v89
    v_cvt_pk_bf16_f32 v85, v90, v91
    v_cvt_pk_bf16_f32 v86, v92, v93
    v_cvt_pk_bf16_f32 v87, v94, v95
    buffer_store_dwordx4 v[84:87], v2, s[20:23], s57 offen offset:3072 sc1
    s_waitcnt vmcnt(5)
    s_mov_b64 exec, 1
    v_mov_b32 v11, 1
    ds_add_u32 v7, v11 offset:4
    s_mov_b64 exec, -1
    s_mov_b32 s47, 0
    s_branch L_nz_1c
L_nz_1:
    buffer_load_dwordx2 v[62:63], v8, s[60:63], 0 offen sc1
    s_waitcnt vmcnt(0)
L_nz_1c:
    v_readfirstlane_b32 s81, v63
    v_readfirstlane_b32 s80, v62
    s_add_u32 s47, s47, 1
    s_cmp_lg_u32 s81, 0
    s_cbranch_scc1 L_nze_2
    s_sleep 2
    s_cmp_lt_u32 s47, 200000
    s_cbranch_scc1 L_nz_1
L_nze_2:
    v_cmp_ne_u64 vcc, s[80:81], v[28:29]
    s_nop 0
    s_mov_b32 s19, vcc_lo
    s_cbranch_vccnz L_cst_3
    s_lshl_b32 s3, s38, 10
    s_add_u32 s3, s3, 17301632
    s_mov_b32 m0, 162432
    v_lshrrev_b32 v10, 5, v1
    v_lshlrev_b32 v10, 7, v10
    v_and_b32 v11, 31, v1
    v_add_lshl_u32 v10, v10, v11, 2
    buffer_load_dword v10, s[20:23], s3 offen sc1 lds
L_cst_3:
    s_setprio 0
    v_xor_b32 v24, 64, v24
    v_add_u32 v16, 98304, v24
    v_add_u32 v17, 32768, v24
    s_mov_b32 s24, s14
    s_and_b32 s25, s15, 0xffff
    s_mov_b32 s26, 1605632
    s_mov_b32 s27, 0x20000
    v_lshrrev_b32 v10, 5, v1
    v_bfe_u32 v11, v1, 2, 2
    v_lshl_add_u32 v10, v10, 2, v11
    v_lshlrev_b32 v10, 7, v10
    v_bfe_u32 v11, v1, 3, 1
    v_lshl_add_u32 v10, v11, 6, v10
    v_bfe_u32 v11, v1, 4, 1
    v_lshl_add_u32 v10, v11, 5, v10
    v_and_b32 v11, 3, v1
    v_lshl_add_u32 v10, v11, 3, v10
    v_add_u32 v5, s49, v10
    v_xor_b32 v6, 64, v5
    v_add_u32 v12, 90112, v5
    v_xor_b32 v13, 64, v12
    s_mul_i32 s3, s42, 229376
    s_add_u32 s3, s3, 6291456
    v_add_u32 v30, s3, v2
    v_add_u32 v31, 114688, v30
    s_mul_i32 s3, s36, 7
    s_lshr_b32 s3, s3, 1
    v_bfe_u32 v10, v1, 1, 2
    v_add_u32 v10, s3, v10
    v_bfe_u32 v14, v1, 3, 1
    s_lshl_b32 s3, s42, 1
    v_add_u32 v14, s3, v14
    v_mul_u32_u24 v14, 14, v14
    v_add_lshl_u32 v14, v14, v10, 1
    v_and_b32 v10, 1, v1
    v_add_lshl_u32 v14, v14, v10, 7
    v_add_u32 v14, 19136512, v14
    ds_read_b64_tr_b16 v[32:33], v16 offset:0
    ds_read_b64_tr_b16 v[34:35], v16 offset:512
    ds_read_b64_tr_b16 v[36:37], v16 offset:2048
    ds_read_b64_tr_b16 v[38:39], v16 offset:2560
    ds_read_b64_tr_b16 v[40:41], v16 offset:4096
    ds_read_b64_tr_b16 v[42:43], v16 offset:4608
    ds_read_b64_tr_b16 v[44:45], v16 offset:6144
    ds_read_b64_tr_b16 v[46:47], v16 offset:6656
    ds_read_b64_tr_b16 v[48:49], v16 offset:8192
    ds_read_b64_tr_b16 v[50:51], v16 offset:8704
    s_waitcnt lgkmcnt(6)
    v_mfma_f32_32x32x16_bf16 v[64:79], v[32:35], v[128:131], 0
    ds_read_b64_tr_b16 v[52:53], v16 offset:10240
    ds_read_b64_tr_b16 v[54:55], v16 offset:10752
    v_mfma_f32_32x32x16_bf16 v[64:79], v[36:39], v[132:135], v[64:79]
    ds_read_b64_tr_b16 v[32:33], v16 offset:12288
    ds_read_b64_tr_b16 v[34:35], v16 offset:12800
    s_waitcnt lgkmcnt(6)
    v_mfma_f32_32x32x16_bf16 v[64:79], v[40:43], v[136:139], v[64:79]
    ds_read_b64_tr_b16 v[36:37], v16 offset:14336
    ds_read_b64_tr_b16 v[38:39], v16 offset:14848
    v_mfma_f32_32x32x16_bf16 v[64:79], v[44:47], v[140:143], v[64:79]
    ds_read_b64_tr_b16 v[40:41], v16 offset:16384
    ds_read_b64_tr_b16 v[42:43], v16 offset:16896
    s_waitcnt lgkmcnt(6)
    v_mfma_f32_32x32x16_bf16 v[64:79], v[48:51], v[144:147], v[64:79]
    ds_read_b64_tr_b16 v[44:45], v16 offset:18432
    ds_read_b64_tr_b16 v[46:47], v16 offset:18944
    v_mfma_f32_32x32x16_bf16 v[64:79], v[52:55], v[148:151], v[64:79]
    ds_read_b64_tr_b16 v[48:49], v16 offset:20480
    ds_read_b64_tr_b16 v[50:51], v16 offset:20992
    s_waitcnt lgkmcnt(6)
    v_mfma_f32_32x32x16_bf16 v[64:79], v[32:35], v[152:155], v[64:79]
    ds_read_b64_tr_b16 v[52:53], v16 offset:22528
    ds_read_b64_tr_b16 v[54:55], v16 offset:23040
    v_mfma_f32_32x32x16_bf16 v[64:79], v[36:39], v[156:159], v[64:79]
    ds_read_b64_tr_b16 v[32:33], v16 offset:24576
    ds_read_b64_tr_b16 v[34:35], v16 offset:25088
    s_waitcnt lgkmcnt(6)
    v_mfma_f32_32x32x16_bf16 v[64:79], v[40:43], v[160:163], v[64:79]
    s_waitcnt vmcnt(0)
    v_lshlrev_b32 v11, 3, v1
    s_mov_b64 exec, 65535
    buffer_store_dwordx2 v[62:63], v11, s[20:23], s59 offen offset:0 sc1
    s_mov_b64 exec, -1
    ds_read_b64_tr_b16 v[36:37], v16 offset:26624
    ds_read_b64_tr_b16 v[38:39], v16 offset:27136
    v_mfma_f32_32x32x16_bf16 v[64:79], v[44:47], v[164:167], v[64:79]
    ds_read_b64_tr_b16 v[40:41], v16 offset:28672
    ds_read_b64_tr_b16 v[42:43], v16 offset:29184
    s_waitcnt lgkmcnt(6)
    v_mfma_f32_32x32x16_bf16 v[64:79], v[48:51], v[168:171], v[64:79]
    s_add_u32 m0, s49, 0
    s_mul_i32 s44, s76, 14
    buffer_load_dwordx4 v3, s[24:27], s44 offen lds
    ds_read_b64_tr_b16 v[44:45], v16 offset:30720
    ds_read_b64_tr_b16 v[46:47], v16 offset:31232
    v_mfma_f32_32x32x16_bf16 v[64:79], v[52:55], v[172:175], v[64:79]
    buffer_load_dwordx4 v4, s[24:27], s44 offen offset:1024 lds
    ds_read_b64_tr_b16 v[48:49], v16 offset:32768
    ds_read_b64_tr_b16 v[50:51], v16 offset:33280
    s_waitcnt lgkmcnt(6)
    v_mfma_f32_32x32x16_bf16 v[64:79], v[32:35], v[176:179], v[64:79]
    ds_read_b64_tr_b16 v[52:53], v16 offset:34816
    ds_read_b64_tr_b16 v[54:55], v16 offset:35328
    v_mfma_f32_32x32x16_bf16 v[64:79], v[36:39], v[180:183], v[64:79]
    s_add_u32 m0, s49, 8192
    s_mul_i32 s44, s77, 14
    buffer_load_dwordx4 v3, s[24:27], s44 offen lds
    ds_read_b64_tr_b16 v[32:33], v16 offset:36864
    ds_read_b64_tr_b16 v[34:35], v16 offset:37376
    s_waitcnt lgkmcnt(6)
    v_mfma_f32_32x32x16_bf16 v[64:79], v[40:43], v[184:187], v[64:79]
    buffer_load_dwordx4 v4, s[24:27], s44 offen offset:1024 lds
    ds_read_b64_tr_b16 v[36:37], v16 offset:38912
    ds_read_b64_tr_b16 v[38:39], v16 offset:39424
    v_mfma_f32_32x32x16_bf16 v[64:79], v[44:47], v[188:191], v[64:79]
    ds_read_b64_tr_b16 v[40:41], v16 offset:40960
    ds_read_b64_tr_b16 v[42:43], v16 offset:41472
    s_waitcnt lgkmcnt(6)
    v_mfma_f32_32x32x16_bf16 v[64:79], v[48:51], v[192:195], v[64:79]
    s_add_u32 m0, s49, 16384
    s_mul_i32 s44, s78, 14
    buffer_load_dwordx4 v3, s[24:27], s44 offen lds
    ds_read_b64_tr_b16 v[44:45], v16 offset:43008
    ds_read_b64_tr_b16 v[46:47], v16 offset:43520
    v_mfma_f32_32x32x16_bf16 v[64:79], v[52:55], v[196:199], v[64:79]
    buffer_load_dwordx4 v4, s[24:27], s44 offen offset:1024 lds
    ds_read_b64_tr_b16 v[48:49], v16 offset:45056
    ds_read_b64_tr_b16 v[50:51], v16 offset:45568
    s_waitcnt lgkmcnt(6)
    v_mfma_f32_32x32x16_bf16 v[64:79], v[32:35], v[200:203], v[64:79]
    ds_read_b64_tr_b16 v[52:53], v16 offset:47104
    ds_read_b64_tr_b16 v[54:55], v16 offset:47616
    v_mfma_f32_32x32x16_bf16 v[64:79], v[36:39], v[204:207], v[64:79]
    s_add_u32 m0, s49, 24576
    s_mul_i32 s44, s79, 14
    buffer_load_dwordx4 v3, s[24:27], s44 offen lds
    ds_read_b64_tr_b16 v[32:33], v16 offset:49152
    ds_read_b64_tr_b16 v[34:35], v16 offset:49664
    s_waitcnt lgkmcnt(6)
    v_mfma_f32_32x32x16_bf16 v[64:79], v[40:43], v[208:211], v[64:79]
    buffer_load_dwordx4 v4, s[24:27], s44 offen offset:1024 lds
    ds_read_b64_tr_b16 v[36:37], v16 offset:51200
    ds_read_b64_tr_b16 v[38:39], v16 offset:51712
    v_mfma_f32_32x32x16_bf16 v[64:79], v[44:47], v[212:215], v[64:79]
    ds_read_b64_tr_b16 v[40:41], v16 offset:53248
    ds_read_b64_tr_b16 v[42:43], v16 offset:53760
    s_waitcnt lgkmcnt(6)
    v_mfma_f32_32x32x16_bf16 v[64:79], v[48:51], v[216:219], v[64:79]
    s_add_u32 m0, s49, 90112
    s_mul_i32 s44, s66, 14
    s_add_u32 s44, s44, 57344
    buffer_load_dwordx4 v3, s[24:27], s44 offen lds
    ds_read_b64_tr_b16 v[44:45], v16 offset:55296
    ds_read_b64_tr_b16 v[46:47], v16 offset:55808
    v_mfma_f32_32x32x16_bf16 v[64:79], v[52:55], v[220:223], v[64:79]
    buffer_load_dwordx4 v4, s[24:27], s44 offen offset:1024 lds
    s_waitcnt lgkmcnt(4)
    v_mfma_f32_32x32x16_bf16 v[64:79], v[32:35], v[224:227], v[64:79]
    v_mfma_f32_32x32x16_bf16 v[64:79], v[36:39], v[228:231], v[64:79]
    s_waitcnt lgkmcnt(0)
    v_mfma_f32_32x32x16_bf16 v[64:79], v[40:43], v[232:235], v[64:79]
    v_mfma_f32_32x32x16_bf16 v[64:79], v[44:47], v[236:239], v[64:79]
    s_mov_b64 exec, 1
    v_mov_b32 v11, 1
    ds_add_u32 v7, v11 offset:8
    s_mov_b64 exec, -1
    s_cmp_eq_u32 s19, 0
    s_cbranch_scc1 L_csl_4
    s_lshl_b32 s44, s38, 10
    s_add_u32 s44, s44, 17301504
    s_mov_b64 exec, 3
    s_mov_b32 s47, 0
L_poll_5:
    buffer_load_dwordx2 v[28:29], v25, s[20:23], s44 offen offset:256 sc1
    s_add_u32 s47, s47, 1
    s_waitcnt vmcnt(0)
    v_cmp_ne_u64 vcc, s[80:81], v[28:29]
    s_nop 0
    s_cbranch_vccz L_polle_6
    s_sleep 4
    s_cmp_lt_u32 s47, 200000
    s_cbranch_scc1 L_poll_5
L_polle_6:
    s_mov_b64 exec, -1
    s_lshl_b32 s3, s38, 10
    s_add_u32 s3, s3, 17301632
    s_mov_b32 m0, 162432
    v_lshrrev_b32 v10, 5, v1
    v_lshlrev_b32 v10, 7, v10
    v_and_b32 v11, 31, v1
    v_add_lshl_u32 v10, v10, v11, 2
    buffer_load_dword v10, s[20:23], s3 offen sc1 lds
    s_waitcnt vmcnt(0)
L_csl_4:
    ds_read_b128 v[240:243], v9 offset:640
    ds_read_b128 v[244:247], v9 offset:672
    ds_read_b128 v[248:251], v9 offset:704
    ds_read_b128 v[252:255], v9 offset:736
    ds_read_b128 v[96:99], v9 offset:768
    ds_read_b128 v[100:103], v9 offset:800
    ds_read_b128 v[104:107], v9 offset:832
    ds_read_b128 v[108:111], v9 offset:864
    s_waitcnt lgkmcnt(4)
    v_fma_f32 v64, v240, v18, v64
    v_fma_f32 v65, v241, v18, v65
    v_fma_f32 v66, v242, v18, v66
    v_fma_f32 v67, v243, v18, v67
    v_mul_f32 v112, v22, v64
    v_mul_f32 v113, v22, v65
    v_mul_f32 v114, v22, v66
    v_mul_f32 v115, v22, v67
    v_exp_f32 v112, v112
    v_exp_f32 v113, v113
    v_exp_f32 v114, v114
    v_exp_f32 v115, v115
    v_fma_f32 v112, v112, v23, v23
    v_fma_f32 v113, v113, v23, v23
    v_fma_f32 v114, v114, v23, v23
    v_fma_f32 v115, v115, v23, v23
    v_rcp_f32 v112, v112
    v_rcp_f32 v113, v113
    v_rcp_f32 v114, v114
    v_rcp_f32 v115, v115
    v_mul_f32 v64, v112, v64
    v_mul_f32 v65, v113, v65
    v_mul_f32 v66, v114, v66
    v_mul_f32 v67, v115, v67
    v_fma_f32 v68, v244, v18, v68
    v_fma_f32 v69, v245, v18, v69
    v_fma_f32 v70, v246, v18, v70
    v_fma_f32 v71, v247, v18, v71
    v_mul_f32 v116, v22, v68
    v_mul_f32 v117, v22, v69
    v_mul_f32 v118, v22, v70
    v_mul_f32 v119, v22, v71
    v_exp_f32 v116, v116
    v_exp_f32 v117, v117
    v_exp_f32 v118, v118
    v_exp_f32 v119, v119
    v_fma_f32 v116, v116, v23, v23
    v_fma_f32 v117, v117, v23, v23
    v_fma_f32 v118, v118, v23, v23
    v_fma_f32 v119, v119, v23, v23
    v_rcp_f32 v116, v116
    v_rcp_f32 v117, v117
    v_rcp_f32 v118, v118
    v_rcp_f32 v119, v119
    v_mul_f32 v68, v116, v68
    v_mul_f32 v69, v117, v69
    v_mul_f32 v70, v118, v70
    v_mul_f32 v71, v119, v71
    v_cvt_pk_bf16_f32 v64, v64, v65
    v_cvt_pk_bf16_f32 v65, v66, v67
    v_cvt_pk_bf16_f32 v66, v68, v69
    v_cvt_pk_bf16_f32 v67, v70, v71
    buffer_store_dwordx4 v[64:67], v2, s[20:23], s58 offen offset:0 sc1
    v_fma_f32 v72, v248, v18, v72
    v_fma_f32 v73, v249, v18, v73
    v_fma_f32 v74, v250, v18, v74
    v_fma_f32 v75, v251, v18, v75
    v_mul_f32 v120, v22, v72
    v_mul_f32 v121, v22, v73
    v_mul_f32 v122, v22, v74
    v_mul_f32 v123, v22, v75
    v_exp_f32 v120, v120
    v_exp_f32 v121, v121
    v_exp_f32 v122, v122
    v_exp_f32 v123, v123
    v_fma_f32 v120, v120, v23, v23
    v_fma_f32 v121, v121, v23, v23
    v_fma_f32 v122, v122, v23, v23
    v_fma_f32 v123, v123, v23, v23
    v_rcp_f32 v120, v120
    v_rcp_f32 v121, v121
    v_rcp_f32 v122, v122
    v_rcp_f32 v123, v123
    v_mul_f32 v72, v120, v72
    v_mul_f32 v73, v121, v73
    v_mul_f32 v74, v122, v74
    v_mul_f32 v75, v123, v75
    v_fma_f32 v76, v252, v18, v76
    v_fma_f32 v77, v253, v18, v77
    v_fma_f32 v78, v254, v18, v78
    v_fma_f32 v79, v255, v18, v79
    v_mul_f32 v124, v22, v76
    v_mul_f32 v125, v22, v77
    v_mul_f32 v126, v22, v78
    v_mul_f32 v127, v22, v79
    v_exp_f32 v124, v124
    v_exp_f32 v125, v125
    v_exp_f32 v126, v126
    v_exp_f32 v127, v127
    v_fma_f32 v124, v124, v23, v23
    v_fma_f32 v125, v125, v23, v23
    v_fma_f32 v126, v126, v23, v23
    v_fma_f32 v127, v127, v23, v23
    v_rcp_f32 v124, v124
    v_rcp_f32 v125, v125
    v_rcp_f32 v126, v126
    v_rcp_f32 v127, v127
    v_mul_f32 v76, v124, v76
    v_mul_f32 v77, v125, v77
    v_mul_f32 v78, v126, v78
    v_mul_f32 v79, v127, v79
    v_cvt_pk_bf16_f32 v68, v72, v73
    v_cvt_pk_bf16_f32 v69, v74, v75
    v_cvt_pk_bf16_f32 v70, v76, v77
    v_cvt_pk_bf16_f32 v71, v78, v79
    buffer_store_dwordx4 v[68:71], v2, s[20:23], s58 offen offset:1024 sc1
    s_add_u32 s58, s58, 4096
    s_mov_b32 s47, 0
L_sp_7:
    ds_read_b32 v11, v7 offset:4
    s_add_u32 s47, s47, 1
    s_waitcnt lgkmcnt(0)
    v_cmp_gt_u32 vcc, 8, v11
    s_nop 0
    s_cbranch_vccz L_spe_8
    s_cmp_lt_u32 s47, 1600000
    s_cbranch_scc1 L_sp_7
L_spe_8:
    s_mov_b32 s47, 0
L_sp_9:
    ds_read_b32 v11, v7 offset:8
    s_add_u32 s47, s47, 1
    s_waitcnt lgkmcnt(0)
    v_cmp_gt_u32 vcc, 8, v11
    s_nop 0
    s_cbranch_vccz L_spe_10
    s_cmp_lt_u32 s47, 1600000
    s_cbranch_scc1 L_sp_9
L_spe_10:
    s_add_u32 m0, s49, 137216
    s_mul_i32 s44, s67, 14
    s_add_u32 s44, s44, 57344
    buffer_load_dwordx4 v3, s[24:27], s44 offen lds
    buffer_load_dwordx4 v4, s[24:27], s44 offen offset:1024 lds
    s_add_u32 m0, s49, 145408
    s_mul_i32 s44, s68, 14
    s_add_u32 s44, s44, 57344
    buffer_load_dwordx4 v3, s[24:27], s44 offen lds
    buffer_load_dwordx4 v4, s[24:27], s44 offen offset:1024 lds
    s_add_u32 m0, s49, 153600
    s_mul_i32 s44, s69, 14
    s_add_u32 s44, s44, 57344
    buffer_load_dwordx4 v3, s[24:27], s44 offen lds
    buffer_load_dwordx4 v4, s[24:27], s44 offen offset:1024 lds
    ds_read_b64_tr_b16 v[32:33], v17 offset:0
    ds_read_b64_tr_b16 v[34:35], v17 offset:512
    ds_read_b64_tr_b16 v[36:37], v17 offset:2048
    ds_read_b64_tr_b16 v[38:39], v17 offset:2560
    ds_read_b64_tr_b16 v[40:41], v17 offset:4096
    ds_read_b64_tr_b16 v[42:43], v17 offset:4608
    ds_read_b64_tr_b16 v[44:45], v17 offset:6144
    ds_read_b64_tr_b16 v[46:47], v17 offset:6656
    ds_read_b64_tr_b16 v[48:49], v17 offset:8192
    ds_read_b64_tr_b16 v[50:51], v17 offset:8704
    s_waitcnt lgkmcnt(6)
    v_mfma_f32_32x32x16_bf16 v[80:95], v[32:35], v[128:131], 0
    ds_read_b64_tr_b16 v[52:53], v17 offset:10240
    ds_read_b64_tr_b16 v[54:55], v17 offset:10752
    v_mfma_f32_32x32x16_bf16 v[80:95], v[36:39], v[132:135], v[80:95]
    ds_read_b64_tr_b16 v[32:33], v17 offset:12288
    ds_read_b64_tr_b16 v[34:35], v17 offset:12800
    s_waitcnt lgkmcnt(6)
    v_mfma_f32_32x32x16_bf16 v[80:95], v[40:43], v[136:139], v[80:95]
    ds_read_b64_tr_b16 v[36:37], v17 offset:14336
    ds_read_b64_tr_b16 v[38:39], v17 offset:14848
    v_mfma_f32_32x32x16_bf16 v[80:95], v[44:47], v[140:143], v[80:95]
    ds_read_b64_tr_b16 v[40:41], v17 offset:16384
    ds_read_b64_tr_b16 v[42:43], v17 offset:16896
    s_waitcnt lgkmcnt(6)
    v_mfma_f32_32x32x16_bf16 v[80:95], v[48:51], v[144:147], v[80:95]
    ds_read_b64_tr_b16 v[44:45], v17 offset:18432
    ds_read_b64_tr_b16 v[46:47], v17 offset:18944
    v_mfma_f32_32x32x16_bf16 v[80:95], v[52:55], v[148:151], v[80:95]
    ds_read_b64_tr_b16 v[48:49], v17 offset:20480
    ds_read_b64_tr_b16 v[50:51], v17 offset:20992
    s_waitcnt lgkmcnt(6)
    v_mfma_f32_32x32x16_bf16 v[80:95], v[32:35], v[152:155], v[80:95]
    ds_read_b64_tr_b16 v[52:53], v17 offset:22528
    ds_read_b64_tr_b16 v[54:55], v17 offset:23040
    v_mfma_f32_32x32x16_bf16 v[80:95], v[36:39], v[156:159], v[80:95]
    ds_read_b64_tr_b16 v[32:33], v17 offset:24576
    ds_read_b64_tr_b16 v[34:35], v17 offset:25088
    s_waitcnt lgkmcnt(6)
    v_mfma_f32_32x32x16_bf16 v[80:95], v[40:43], v[160:163], v[80:95]
    ds_read_b64_tr_b16 v[36:37], v17 offset:26624
    ds_read_b64_tr_b16 v[38:39], v17 offset:27136
    v_mfma_f32_32x32x16_bf16 v[80:95], v[44:47], v[164:167], v[80:95]
    ds_read_b64_tr_b16 v[40:41], v17 offset:28672
    ds_read_b64_tr_b16 v[42:43], v17 offset:29184
    s_waitcnt lgkmcnt(6)
    v_mfma_f32_32x32x16_bf16 v[80:95], v[48:51], v[168:171], v[80:95]
    ds_read_b64_tr_b16 v[44:45], v17 offset:30720
    ds_read_b64_tr_b16 v[46:47], v17 offset:31232
    v_mfma_f32_32x32x16_bf16 v[80:95], v[52:55], v[172:175], v[80:95]
    ds_read_b64_tr_b16 v[48:49], v17 offset:32768
    ds_read_b64_tr_b16 v[50:51], v17 offset:33280
    s_waitcnt lgkmcnt(6)
    v_mfma_f32_32x32x16_bf16 v[80:95], v[32:35], v[176:179], v[80:95]
    ds_read_b64_tr_b16 v[52:53], v17 offset:34816
    ds_read_b64_tr_b16 v[54:55], v17 offset:35328
    v_mfma_f32_32x32x16_bf16 v[80:95], v[36:39], v[180:183], v[80:95]
    ds_read_b64_tr_b16 v[32:33], v17 offset:36864
    ds_read_b64_tr_b16 v[34:35], v17 offset:37376
    s_waitcnt lgkmcnt(6)
    v_mfma_f32_32x32x16_bf16 v[80:95], v[40:43], v[184:187], v[80:95]
    ds_read_b64_tr_b16 v[36:37], v17 offset:38912
    ds_read_b64_tr_b16 v[38:39], v17 offset:39424
    v_mfma_f32_32x32x16_bf16 v[80:95], v[44:47], v[188:191], v[80:95]
    ds_read_b64_tr_b16 v[40:41], v17 offset:40960
    ds_read_b64_tr_b16 v[42:43], v17 offset:41472
    s_waitcnt lgkmcnt(6)
    v_mfma_f32_32x32x16_bf16 v[80:95], v[48:51], v[192:195], v[80:95]
    ds_read_b64_tr_b16 v[44:45], v17 offset:43008
    ds_read_b64_tr_b16 v[46:47], v17 offset:43520
    v_mfma_f32_32x32x16_bf16 v[80:95], v[52:55], v[196:199], v[80:95]
    ds_read_b64_tr_b16 v[48:49], v17 offset:45056
    ds_read_b64_tr_b16 v[50:51], v17 offset:45568
    s_waitcnt lgkmcnt(6)
    v_mfma_f32_32x32x16_bf16 v[80:95], v[32:35], v[200:203], v[80:95]
    ds_read_b64_tr_b16 v[52:53], v17 offset:47104
    ds_read_b64_tr_b16 v[54:55], v17 offset:47616
    v_mfma_f32_32x32x16_bf16 v[80:95], v[36:39], v[204:207], v[80:95]
    ds_read_b64_tr_b16 v[32:33], v17 offset:49152
    ds_read_b64_tr_b16 v[34:35], v17 offset:49664
    s_waitcnt lgkmcnt(6)
    v_mfma_f32_32x32x16_bf16 v[80:95], v[40:43], v[208:211], v[80:95]
    ds_read_b64_tr_b16 v[36:37], v17 offset:51200
    ds_read_b64_tr_b16 v[38:39], v17 offset:51712
    v_mfma_f32_32x32x16_bf16 v[80:95], v[44:47], v[212:215], v[80:95]
    ds_read_b64_tr_b16 v[40:41], v17 offset:53248
    ds_read_b64_tr_b16 v[42:43], v17 offset:53760
    s_waitcnt lgkmcnt(6)
    v_mfma_f32_32x32x16_bf16 v[80:95], v[48:51], v[216:219], v[80:95]
    ds_read_b64_tr_b16 v[44:45], v17 offset:55296
    ds_read_b64_tr_b16 v[46:47], v17 offset:55808
    v_mfma_f32_32x32x16_bf16 v[80:95], v[52:55], v[220:223], v[80:95]
    s_waitcnt lgkmcnt(4)
    v_mfma_f32_32x32x16_bf16 v[80:95], v[32:35], v[224:227], v[80:95]
    v_mfma_f32_32x32x16_bf16 v[80:95], v[36:39], v[228:231], v[80:95]
    s_waitcnt lgkmcnt(0)
    v_mfma_f32_32x32x16_bf16 v[80:95], v[40:43], v[232:235], v[80:95]
    v_mfma_f32_32x32x16_bf16 v[80:95], v[44:47], v[236:239], v[80:95]
    s_waitcnt vmcnt(6)
    v_lshlrev_b32 v11, 3, v1
    v_add_u32 v11, 262144, v11
    s_mov_b64 exec, 65535
    buffer_store_dwordx2 v[62:63], v11, s[20:23], s59 offen offset:0 sc1
    s_mov_b64 exec, -1
    s_mov_b64 exec, 1
    v_mov_b32 v11, 1
    ds_add_u32 v7, v11 offset:12
    s_mov_b64 exec, -1
    s_setprio 3
    s_nop 0
    v_fma_f32 v80, v96, v18, v80
    v_fma_f32 v81, v97, v18, v81
    v_fma_f32 v82, v98, v18, v82
    v_fma_f32 v83, v99, v18, v83
    v_mul_f32 v112, v22, v80
    v_mul_f32 v113, v22, v81
    v_mul_f32 v114, v22, v82
    v_mul_f32 v115, v22, v83
    v_exp_f32 v112, v112
    v_exp_f32 v113, v113
    v_exp_f32 v114, v114
    v_exp_f32 v115, v115
    v_fma_f32 v112, v112, v23, v23
    v_fma_f32 v113, v113, v23, v23
    v_fma_f32 v114, v114, v23, v23
    v_fma_f32 v115, v115, v23, v23
    v_rcp_f32 v112, v112
    v_rcp_f32 v113, v113
    v_rcp_f32 v114, v114
    v_rcp_f32 v115, v115
    v_mul_f32 v80, v112, v80
    v_mul_f32 v81, v113, v81
    v_mul_f32 v82, v114, v82
    v_mul_f32 v83, v115, v83
    v_fma_f32 v84, v100, v18, v84
    v_fma_f32 v85, v101, v18, v85
    v_fma_f32 v86, v102, v18, v86
    v_fma_f32 v87, v103, v18, v87
    v_mul_f32 v116, v22, v84
    v_mul_f32 v117, v22, v85
    v_mul_f32 v118, v22, v86
    v_mul_f32 v119, v22, v87
    v_exp_f32 v116, v116
    v_exp_f32 v117, v117
    v_exp_f32 v118, v118
    v_exp_f32 v119, v119
    v_fma_f32 v116, v116, v23, v23
    v_fma_f32 v117, v117, v23, v23
    v_fma_f32 v118, v118, v23, v23
    v_fma_f32 v119, v119, v23, v23
    v_rcp_f32 v116, v116
    v_rcp_f32 v117, v117
    v_rcp_f32 v118, v118
    v_rcp_f32 v119, v119
    v_mul_f32 v84, v116, v84
    v_mul_f32 v85, v117, v85
    v_mul_f32 v86, v118, v86
    v_mul_f32 v87, v119, v87
    v_cvt_pk_bf16_f32 v80, v80, v81
    v_cvt_pk_bf16_f32 v81, v82, v83
    v_cvt_pk_bf16_f32 v82, v84, v85
    v_cvt_pk_bf16_f32 v83, v86, v87
    buffer_store_dwordx4 v[80:83], v2, s[20:23], s58 offen offset:0 sc1
    v_fma_f32 v88, v104, v18, v88
    v_fma_f32 v89, v105, v18, v89
    v_fma_f32 v90, v106, v18, v90
    v_fma_f32 v91, v107, v18, v91
    v_mul_f32 v120, v22, v88
    v_mul_f32 v121, v22, v89
    v_mul_f32 v122, v22, v90
    v_mul_f32 v123, v22, v91
    v_exp_f32 v120, v120
    v_exp_f32 v121, v121
    v_exp_f32 v122, v122
    v_exp_f32 v123, v123
    v_fma_f32 v120, v120, v23, v23
    v_fma_f32 v121, v121, v23, v23
    v_fma_f32 v122, v122, v23, v23
    v_fma_f32 v123, v123, v23, v23
    v_rcp_f32 v120, v120
    v_rcp_f32 v121, v121
    v_rcp_f32 v122, v122
    v_rcp_f32 v123, v123
    v_mul_f32 v88, v120, v88
    v_mul_f32 v89, v121, v89
    v_mul_f32 v90, v122, v90
    v_mul_f32 v91, v123, v91
    v_fma_f32 v92, v108, v18, v92
    v_fma_f32 v93, v109, v18, v93
    v_fma_f32 v94, v110, v18, v94
    v_fma_f32 v95, v111, v18, v95
    v_mul_f32 v124, v22, v92
    v_mul_f32 v125, v22, v93
    v_mul_f32 v126, v22, v94
    v_mul_f32 v127, v22, v95
    v_exp_f32 v124, v124
    v_exp_f32 v125, v125
    v_exp_f32 v126, v126
    v_exp_f32 v127, v127
    v_fma_f32 v124, v124, v23, v23
    v_fma_f32 v125, v125, v23, v23
    v_fma_f32 v126, v126, v23, v23
    v_fma_f32 v127, v127, v23, v23
    v_rcp_f32 v124, v124
    v_rcp_f32 v125, v125
    v_rcp_f32 v126, v126
    v_rcp_f32 v127, v127
    v_mul_f32 v92, v124, v92
    v_mul_f32 v93, v125, v93
    v_mul_f32 v94, v126, v94
    v_mul_f32 v95, v127, v95
    v_cvt_pk_bf16_f32 v84, v88, v89
    v_cvt_pk_bf16_f32 v85, v90, v91
    v_cvt_pk_bf16_f32 v86, v92, v93
    v_cvt_pk_bf16_f32 v87, v94, v95
    buffer_store_dwordx4 v[84:87], v2, s[20:23], s58 offen offset:1024 sc1
    s_setprio 1
    s_mov_b32 s47, 0
L_sp_11:
    ds_read_b32 v11, v7 offset:12
    s_add_u32 s47, s47, 1
    s_waitcnt lgkmcnt(0)
    v_cmp_gt_u32 vcc, 8, v11
    s_nop 0
    s_cbranch_vccz L_spe_12
    s_cmp_lt_u32 s47, 1600000
    s_cbranch_scc1 L_sp_11
L_spe_12:
    s_add_u32 m0, s49, 32768
    s_mul_i32 s44, s66, 14
    buffer_load_dwordx4 v3, s[24:27], s44 offen lds
    buffer_load_dwordx4 v4, s[24:27], s44 offen offset:1024 lds
    s_add_u32 m0, s49, 40960
    s_mul_i32 s44, s67, 14
    buffer_load_dwordx4 v3, s[24:27], s44 offen lds
    buffer_load_dwordx4 v4, s[24:27], s44 offen offset:1024 lds
    ds_read_b64_tr_b16 v[248:249], v5 offset:0
    ds_read_b64_tr_b16 v[250:251], v5 offset:1024
    ds_read_b64_tr_b16 v[252:253], v6 offset:0
    ds_read_b64_tr_b16 v[254:255], v6 offset:1024
    ds_read_b64_tr_b16 v[240:241], v5 offset:8192
    ds_read_b64_tr_b16 v[242:243], v5 offset:9216
    ds_read_b64_tr_b16 v[244:245], v6 offset:8192
    ds_read_b64_tr_b16 v[246:247], v6 offset:9216
    ds_read_b64_tr_b16 v[232:233], v5 offset:16384
    ds_read_b64_tr_b16 v[234:235], v5 offset:17408
    ds_read_b64_tr_b16 v[236:237], v6 offset:16384
    ds_read_b64_tr_b16 v[238:239], v6 offset:17408
    ds_read_b64_tr_b16 v[224:225], v5 offset:24576
    ds_read_b64_tr_b16 v[226:227], v5 offset:25600
    ds_read_b64_tr_b16 v[228:229], v6 offset:24576
    ds_read_b64_tr_b16 v[230:231], v6 offset:25600
    ds_read_b64_tr_b16 v[216:217], v12 offset:0
    ds_read_b64_tr_b16 v[218:219], v12 offset:1024
    ds_read_b64_tr_b16 v[220:221], v13 offset:0
    ds_read_b64_tr_b16 v[222:223], v13 offset:1024
    s_waitcnt vmcnt(11)
    ds_read_b64_tr_b16 v[208:209], v12 offset:47104
    ds_read_b64_tr_b16 v[210:211], v12 offset:48128
    ds_read_b64_tr_b16 v[212:213], v13 offset:47104
    ds_read_b64_tr_b16 v[214:215], v13 offset:48128
    s_waitcnt vmcnt(9)
    ds_read_b64_tr_b16 v[200:201], v12 offset:55296
    ds_read_b64_tr_b16 v[202:203], v12 offset:56320
    ds_read_b64_tr_b16 v[204:205], v13 offset:55296
    ds_read_b64_tr_b16 v[206:207], v13 offset:56320
    s_waitcnt vmcnt(7)
    ds_read_b64_tr_b16 v[192:193], v12 offset:63488
    ds_read_b64_tr_b16 v[194:195], v12 offset:64512
    ds_read_b64_tr_b16 v[196:197], v13 offset:63488
    ds_read_b64_tr_b16 v[198:199], v13 offset:64512
    s_waitcnt lgkmcnt(0)
    s_add_u32 m0, s49, 0
    s_mul_i32 s44, s68, 14
    buffer_load_dwordx4 v3, s[24:27], s44 offen lds
    buffer_load_dwordx4 v4, s[24:27], s44 offen offset:1024 lds
    s_waitcnt vmcnt(6)
    v_lshlrev_b32 v11, 3, v1
    v_add_u32 v11, 524288, v11
    s_mov_b64 exec, 65535
    buffer_store_dwordx2 v[62:63], v11, s[20:23], s59 offen offset:0 sc1
    s_mov_b64 exec, -1
    s_add_u32 m0, s49, 8192
    s_mul_i32 s44, s69, 14
    buffer_load_dwordx4 v3, s[24:27], s44 offen lds
    buffer_load_dwordx4 v4, s[24:27], s44 offen offset:1024 lds
    s_add_u32 m0, s49, 16384
    s_mul_i32 s44, s70, 14
    buffer_load_dwordx4 v3, s[24:27], s44 offen lds
    buffer_load_dwordx4 v4, s[24:27], s44 offen offset:1024 lds
    s_add_u32 m0, s49, 24576
    s_mul_i32 s44, s71, 14
    buffer_load_dwordx4 v3, s[24:27], s44 offen lds
    buffer_load_dwordx4 v4, s[24:27], s44 offen offset:1024 lds
    s_add_u32 m0, s49, 90112
    s_mul_i32 s44, s72, 14
    buffer_load_dwordx4 v3, s[24:27], s44 offen lds
    buffer_load_dwordx4 v4, s[24:27], s44 offen offset:1024 lds
    s_add_u32 m0, s49, 137216
    s_mul_i32 s44, s73, 14
    buffer_load_dwordx4 v3, s[24:27], s44 offen lds
    buffer_load_dwordx4 v4, s[24:27], s44 offen offset:1024 lds
    buffer_load_dwordx2 v[28:29], v14, s[20:23], 0 offen sc1
    s_add_u32 m0, s49, 145408
    s_mul_i32 s44, s74, 14
    buffer_load_dwordx4 v3, s[24:27], s44 offen lds
    buffer_load_dwordx4 v4, s[24:27], s44 offen offset:1024 lds
    s_add_u32 m0, s49, 153600
    s_mul_i32 s44, s75, 14
    buffer_load_dwordx4 v3, s[24:27], s44 offen lds
    buffer_load_dwordx4 v4, s[24:27], s44 offen offset:1024 lds
    s_waitcnt vmcnt(4)
    v_cmp_ne_u64 vcc, s[80:81], v[28:29]
    s_nop 0
    s_cbranch_vccz L_hok_13
    s_mov_b64 exec, 65535
    s_mov_b32 s47, 0
L_poll_14:
    buffer_load_dwordx2 v[28:29], v14, s[20:23], 0 offen offset:0 sc1
    s_add_u32 s47, s47, 1
    s_waitcnt vmcnt(0)
    v_cmp_ne_u64 vcc, s[80:81], v[28:29]
    s_nop 0
    s_cbranch_vccz L_polle_15
    s_sleep 4
    s_cmp_lt_u32 s47, 200000
    s_cbranch_scc1 L_poll_14
L_polle_15:
    s_mov_b64 exec, -1
L_hok_13:
    buffer_load_dwordx4 v[128:131], v30, s[20:23], s66 offen sc1
    buffer_load_dwordx4 v[132:135], v31, s[20:23], s66 offen sc1
    buffer_load_dwordx4 v[136:139], v30, s[20:23], s67 offen sc1
    buffer_load_dwordx4 v[140:143], v31, s[20:23], s67 offen sc1
    buffer_load_dwordx4 v[144:147], v30, s[20:23], s68 offen sc1
    buffer_load_dwordx4 v[148:151], v31, s[20:23], s68 offen sc1
    buffer_load_dwordx4 v[152:155], v30, s[20:23], s69 offen sc1
    buffer_load_dwordx4 v[156:159], v31, s[20:23], s69 offen sc1
    buffer_load_dwordx4 v[160:163], v30, s[20:23], s70 offen sc1
    buffer_load_dwordx4 v[164:167], v31, s[20:23], s70 offen sc1
    buffer_load_dwordx4 v[168:171], v30, s[20:23], s71 offen sc1
    buffer_load_dwordx4 v[172:175], v31, s[20:23], s71 offen sc1
    buffer_load_dwordx4 v[176:179], v30, s[20:23], s72 offen sc1
    buffer_load_dwordx4 v[180:183], v31, s[20:23], s72 offen sc1
    ds_read_b64_tr_b16 v[32:33], v5 offset:32768
    ds_read_b64_tr_b16 v[34:35], v5 offset:33792
    ds_read_b64_tr_b16 v[36:37], v6 offset:32768
    ds_read_b64_tr_b16 v[38:39], v6 offset:33792
    s_waitcnt vmcnt(12) lgkmcnt(0)
    v_mfma_f32_32x32x16_bf16 v[64:79], v[32:35], v[128:131], 0
    ds_read_b64_tr_b16 v[40:41], v5 offset:40960
    ds_read_b64_tr_b16 v[42:43], v5 offset:41984
    buffer_load_dwordx4 v[184:187], v30, s[20:23], s73 offen sc1
    v_mfma_f32_32x32x16_bf16 v[80:95], v[36:39], v[128:131], 0
    ds_read_b64_tr_b16 v[44:45], v6 offset:40960
    ds_read_b64_tr_b16 v[46:47], v6 offset:41984
    buffer_load_dwordx4 v[188:191], v31, s[20:23], s73 offen sc1
    v_mfma_f32_32x32x16_bf16 v[96:111], v[32:35], v[132:135], 0
    s_add_u32 m0, s49, 32768
    s_mul_i32 s44, s70, 14
    s_add_u32 s44, s44, 57344
    buffer_load_dwordx4 v3, s[24:27], s44 offen lds
    v_mfma_f32_32x32x16_bf16 v[112:127], v[36:39], v[132:135], 0
    buffer_load_dwordx4 v4, s[24:27], s44 offen offset:1024 lds
    s_waitcnt vmcnt(14) lgkmcnt(0)
    v_mfma_f32_32x32x16_bf16 v[64:79], v[40:43], v[136:139], v[64:79]
    ds_read_b64_tr_b16 v[32:33], v5 offset:0
    ds_read_b64_tr_b16 v[34:35], v5 offset:1024
    buffer_load_dwordx4 v[128:131], v30, s[20:23], s74 offen sc1
    v_mfma_f32_32x32x16_bf16 v[80:95], v[44:47], v[136:139], v[80:95]
    ds_read_b64_tr_b16 v[36:37], v6 offset:0
    ds_read_b64_tr_b16 v[38:39], v6 offset:1024
    buffer_load_dwordx4 v[132:135], v31, s[20:23], s74 offen sc1
    v_mfma_f32_32x32x16_bf16 v[96:111], v[40:43], v[140:143], v[96:111]
    s_add_u32 m0, s49, 40960
    s_mul_i32 s44, s71, 14
    s_add_u32 s44, s44, 57344
    buffer_load_dwordx4 v3, s[24:27], s44 offen lds
    v_mfma_f32_32x32x16_bf16 v[112:127], v[44:47], v[140:143], v[112:127]
    buffer_load_dwordx4 v4, s[24:27], s44 offen offset:1024 lds
    s_waitcnt vmcnt(16) lgkmcnt(0)
    v_mfma_f32_32x32x16_bf16 v[64:79], v[32:35], v[144:147], v[64:79]
    ds_read_b64_tr_b16 v[40:41], v5 offset:8192
    ds_read_b64_tr_b16 v[42:43], v5 offset:9216
    buffer_load_dwordx4 v[136:139], v30, s[20:23], s75 offen sc1
    v_mfma_f32_32x32x16_bf16 v[80:95], v[36:39], v[144:147], v[80:95]
    ds_read_b64_tr_b16 v[44:45], v6 offset:8192
    ds_read_b64_tr_b16 v[46:47], v6 offset:9216
    buffer_load_dwordx4 v[140:143], v31, s[20:23], s75 offen sc1
    v_mfma_f32_32x32x16_bf16 v[96:111], v[32:35], v[148:151], v[96:111]
    s_add_u32 m0, s49, 0
    s_mul_i32 s44, s72, 14
    s_add_u32 s44, s44, 57344
    buffer_load_dwordx4 v3, s[24:27], s44 offen lds
    v_mfma_f32_32x32x16_bf16 v[112:127], v[36:39], v[148:151], v[112:127]
    buffer_load_dwordx4 v4, s[24:27], s44 offen offset:1024 lds
    s_waitcnt vmcnt(18) lgkmcnt(0)
    v_mfma_f32_32x32x16_bf16 v[64:79], v[40:43], v[152:155], v[64:79]
    ds_read_b64_tr_b16 v[32:33], v5 offset:16384
    ds_read_b64_tr_b16 v[34:35], v5 offset:17408
    buffer_load_dwordx4 v[144:147], v30, s[20:23], s76 offen sc1
    v_mfma_f32_32x32x16_bf16 v[80:95], v[44:47], v[152:155], v[80:95]
    ds_read_b64_tr_b16 v[36:37], v6 offset:16384
    ds_read_b64_tr_b16 v[38:39], v6 offset:17408
    buffer_load_dwordx4 v[148:151], v31, s[20:23], s76 offen sc1
    v_mfma_f32_32x32x16_bf16 v[96:111], v[40:43], v[156:159], v[96:111]
    s_add_u32 m0, s49, 8192
    s_mul_i32 s44, s73, 14
    s_add_u32 s44, s44, 57344
    buffer_load_dwordx4 v3, s[24:27], s44 offen lds
    v_mfma_f32_32x32x16_bf16 v[112:127], v[44:47], v[156:159], v[112:127]
    buffer_load_dwordx4 v4, s[24:27], s44 offen offset:1024 lds
    s_waitcnt vmcnt(20) lgkmcnt(0)
    v_mfma_f32_32x32x16_bf16 v[64:79], v[32:35], v[160:163], v[64:79]
    ds_read_b64_tr_b16 v[40:41], v5 offset:24576
    ds_read_b64_tr_b16 v[42:43], v5 offset:25600
    buffer_load_dwordx4 v[152:155], v30, s[20:23], s77 offen sc1
    buffer_load_dwordx4 v[156:159], v31, s[20:23], s77 offen sc1
    v_mfma_f32_32x32x16_bf16 v[80:95], v[36:39], v[160:163], v[80:95]
    ds_read_b64_tr_b16 v[44:45], v6 offset:24576
    ds_read_b64_tr_b16 v[46:47], v6 offset:25600
    s_add_u32 m0, s49, 16384
    s_mul_i32 s44, s74, 14
    s_add_u32 s44, s44, 57344
    buffer_load_dwordx4 v3, s[24:27], s44 offen lds
    v_mfma_f32_32x32x16_bf16 v[96:111], v[32:35], v[164:167], v[96:111]
    buffer_load_dwordx4 v4, s[24:27], s44 offen offset:1024 lds
    v_mfma_f32_32x32x16_bf16 v[112:127], v[36:39], v[164:167], v[112:127]
    v_add_u32 v14, 262144, v14
    buffer_load_dwordx2 v[28:29], v14, s[20:23], 0 offen sc1
    s_waitcnt vmcnt(23) lgkmcnt(0)
    v_mfma_f32_32x32x16_bf16 v[64:79], v[40:43], v[168:171], v[64:79]
    ds_read_b64_tr_b16 v[32:33], v12 offset:0
    ds_read_b64_tr_b16 v[34:35], v12 offset:1024
    buffer_load_dwordx4 v[160:163], v30, s[20:23], s78 offen sc1
    v_mfma_f32_32x32x16_bf16 v[80:95], v[44:47], v[168:171], v[80:95]
    ds_read_b64_tr_b16 v[36:37], v13 offset:0
    ds_read_b64_tr_b16 v[38:39], v13 offset:1024
    buffer_load_dwordx4 v[164:167], v31, s[20:23], s78 offen sc1
    v_mfma_f32_32x32x16_bf16 v[96:111], v[40:43], v[172:175], v[96:111]
    s_add_u32 m0, s49, 24576
    s_mul_i32 s44, s75, 14
    s_add_u32 s44, s44, 57344
    buffer_load_dwordx4 v3, s[24:27], s44 offen lds
    v_mfma_f32_32x32x16_bf16 v[112:127], v[44:47], v[172:175], v[112:127]
    buffer_load_dwordx4 v4, s[24:27], s44 offen offset:1024 lds
    s_waitcnt vmcnt(25) lgkmcnt(0)
    v_mfma_f32_32x32x16_bf16 v[64:79], v[32:35], v[176:179], v[64:79]
    ds_read_b64_tr_b16 v[40:41], v12 offset:47104
    ds_read_b64_tr_b16 v[42:43], v12 offset:48128
    buffer_load_dwordx4 v[168:171], v30, s[20:23], s79 offen sc1
    v_mfma_f32_32x32x16_bf16 v[80:95], v[36:39], v[176:179], v[80:95]
    ds_read_b64_tr_b16 v[44:45], v13 offset:47104
    ds_read_b64_tr_b16 v[46:47], v13 offset:48128
    buffer_load_dwordx4 v[172:175], v31, s[20:23], s79 offen sc1
    v_mfma_f32_32x32x16_bf16 v[96:111], v[32:35], v[180:183], v[96:111]
    s_add_u32 m0, s49, 90112
    s_mul_i32 s44, s76, 14
    s_add_u32 s44, s44, 57344
    buffer_load_dwordx4 v3, s[24:27], s44 offen lds
    v_mfma_f32_32x32x16_bf16 v[112:127], v[36:39], v[180:183], v[112:127]
    buffer_load_dwordx4 v4, s[24:27], s44 offen offset:1024 lds
    s_waitcnt vmcnt(8)
    v_cmp_ne_u64 vcc, s[80:81], v[28:29]
    s_nop 0
    s_cbranch_vccz L_hok_16
    s_mov_b64 exec, 65535
    s_mov_b32 s47, 0
L_poll_17:
    buffer_load_dwordx2 v[28:29], v14, s[20:23], 0 offen offset:0 sc1
    s_add_u32 s47, s47, 1
    s_waitcnt vmcnt(0)
    v_cmp_ne_u64 vcc, s[80:81], v[28:29]
    s_nop 0
    s_cbranch_vccz L_polle_18
    s_sleep 4
    s_cmp_lt_u32 s47, 200000
    s_cbranch_scc1 L_poll_17
L_polle_18:
    s_mov_b64 exec, -1
L_hok_16:
    s_waitcnt lgkmcnt(0)
    v_mfma_f32_32x32x16_bf16 v[64:79], v[40:43], v[184:187], v[64:79]
    ds_read_b64_tr_b16 v[32:33], v12 offset:55296
    ds_read_b64_tr_b16 v[34:35], v12 offset:56320
    v_add_u32 v30, 4096, v30
    v_add_u32 v31, 4096, v31
    buffer_load_dwordx4 v[176:179], v30, s[20:23], s66 offen sc1
    v_mfma_f32_32x32x16_bf16 v[80:95], v[44:47], v[184:187], v[80:95]
    ds_read_b64_tr_b16 v[36:37], v13 offset:55296
    ds_read_b64_tr_b16 v[38:39], v13 offset:56320
    buffer_load_dwordx4 v[180:183], v31, s[20:23], s66 offen sc1
    v_mfma_f32_32x32x16_bf16 v[96:111], v[40:43], v[188:191], v[96:111]
    s_add_u32 m0, s49, 137216
    s_mul_i32 s44, s77, 14
    s_add_u32 s44, s44, 57344
    buffer_load_dwordx4 v3, s[24:27], s44 offen lds
    v_mfma_f32_32x32x16_bf16 v[112:127], v[44:47], v[188:191], v[112:127]
    buffer_load_dwordx4 v4, s[24:27], s44 offen offset:1024 lds
    s_waitcnt lgkmcnt(0)
    v_mfma_f32_32x32x16_bf16 v[64:79], v[32:35], v[128:131], v[64:79]
    ds_read_b64_tr_b16 v[40:41], v12 offset:63488
    ds_read_b64_tr_b16 v[42:43], v12 offset:64512
    buffer_load_dwordx4 v[184:187], v30, s[20:23], s67 offen sc1
    v_mfma_f32_32x32x16_bf16 v[80:95], v[36:39], v[128:131], v[80:95]
    ds_read_b64_tr_b16 v[44:45], v13 offset:63488
    ds_read_b64_tr_b16 v[46:47], v13 offset:64512
    buffer_load_dwordx4 v[188:191], v31, s[20:23], s67 offen sc1
    v_mfma_f32_32x32x16_bf16 v[96:111], v[32:35], v[132:135], v[96:111]
    s_add_u32 m0, s49, 145408
    s_mul_i32 s44, s78, 14
    s_add_u32 s44, s44, 57344
    buffer_load_dwordx4 v3, s[24:27], s44 offen lds
    v_mfma_f32_32x32x16_bf16 v[112:127], v[36:39], v[132:135], v[112:127]
    buffer_load_dwordx4 v4, s[24:27], s44 offen offset:1024 lds
    s_waitcnt lgkmcnt(0)
    v_mfma_f32_32x32x16_bf16 v[64:79], v[40:43], v[136:139], v[64:79]
    buffer_load_dwordx4 v[128:131], v30, s[20:23], s68 offen sc1
    v_mfma_f32_32x32x16_bf16 v[80:95], v[44:47], v[136:139], v[80:95]
    buffer_load_dwordx4 v[132:135], v31, s[20:23], s68 offen sc1
    v_mfma_f32_32x32x16_bf16 v[96:111], v[40:43], v[140:143], v[96:111]
    s_add_u32 m0, s49, 153600
    s_mul_i32 s44, s79, 14
    s_add_u32 s44, s44, 57344
    buffer_load_dwordx4 v3, s[24:27], s44 offen lds
    v_mfma_f32_32x32x16_bf16 v[112:127], v[44:47], v[140:143], v[112:127]
    buffer_load_dwordx4 v4, s[24:27], s44 offen offset:1024 lds
    v_mfma_f32_32x32x16_bf16 v[64:79], v[248:251], v[144:147], v[64:79]
    buffer_load_dwordx4 v[136:139], v30, s[20:23], s69 offen sc1
    v_mfma_f32_32x32x16_bf16 v[80:95], v[252:255], v[144:147], v[80:95]
    v_mfma_f32_32x32x16_bf16 v[96:111], v[248:251], v[148:151], v[96:111]
    buffer_load_dwordx4 v[140:143], v31, s[20:23], s69 offen sc1
    v_mfma_f32_32x32x16_bf16 v[112:127], v[252:255], v[148:151], v[112:127]
    v_mfma_f32_32x32x16_bf16 v[64:79], v[240:243], v[152:155], v[64:79]
    buffer_load_dwordx4 v[144:147], v30, s[20:23], s70 offen sc1
    v_mfma_f32_32x32x16_bf16 v[80:95], v[244:247], v[152:155], v[80:95]
    v_mfma_f32_32x32x16_bf16 v[96:111], v[240:243], v[156:159], v[96:111]
    buffer_load_dwordx4 v[148:151], v31, s[20:23], s70 offen sc1
    v_mfma_f32_32x32x16_bf16 v[112:127], v[244:247], v[156:159], v[112:127]
    s_waitcnt vmcnt(22)
    v_mfma_f32_32x32x16_bf16 v[64:79], v[232:235], v[160:163], v[64:79]
    buffer_load_dwordx4 v[152:155], v30, s[20:23], s71 offen sc1
    v_mfma_f32_32x32x16_bf16 v[80:95], v[236:239], v[160:163], v[80:95]
    v_mfma_f32_32x32x16_bf16 v[96:111], v[232:235], v[164:167], v[96:111]
    buffer_load_dwordx4 v[156:159], v31, s[20:23], s71 offen sc1
    v_mfma_f32_32x32x16_bf16 v[112:127], v[236:239], v[164:167], v[112:127]
    s_waitcnt vmcnt(20)
    v_mfma_f32_32x32x16_bf16 v[64:79], v[224:227], v[168:171], v[64:79]
    buffer_load_dwordx4 v[160:163], v30, s[20:23], s72 offen sc1
    v_mfma_f32_32x32x16_bf16 v[80:95], v[228:231], v[168:171], v[80:95]
    v_mfma_f32_32x32x16_bf16 v[96:111], v[224:227], v[172:175], v[96:111]
    buffer_load_dwordx4 v[164:167], v31, s[20:23], s72 offen sc1
    v_mfma_f32_32x32x16_bf16 v[112:127], v[228:231], v[172:175], v[112:127]
    s_waitcnt vmcnt(18)
    v_mfma_f32_32x32x16_bf16 v[64:79], v[216:219], v[176:179], v[64:79]
    buffer_load_dwordx4 v[168:171], v30, s[20:23], s73 offen sc1
    v_mfma_f32_32x32x16_bf16 v[80:95], v[220:223], v[176:179], v[80:95]
    v_mfma_f32_32x32x16_bf16 v[96:111], v[216:219], v[180:183], v[96:111]
    buffer_load_dwordx4 v[172:175], v31, s[20:23], s73 offen sc1
    v_mfma_f32_32x32x16_bf16 v[112:127], v[220:223], v[180:183], v[112:127]
    s_waitcnt vmcnt(16)
    v_mfma_f32_32x32x16_bf16 v[64:79], v[208:211], v[184:187], v[64:79]
    buffer_load_dwordx4 v[176:179], v30, s[20:23], s74 offen sc1
    v_mfma_f32_32x32x16_bf16 v[80:95], v[212:215], v[184:187], v[80:95]
    v_mfma_f32_32x32x16_bf16 v[96:111], v[208:211], v[188:191], v[96:111]
    buffer_load_dwordx4 v[180:183], v31, s[20:23], s74 offen sc1
    v_mfma_f32_32x32x16_bf16 v[112:127], v[212:215], v[188:191], v[112:127]
    s_mov_b64 exec, 1
    v_mov_b32 v11, 1
    ds_add_u32 v7, v11 offset:0
    s_mov_b64 exec, -1
    s_waitcnt vmcnt(14)
    v_mfma_f32_32x32x16_bf16 v[64:79], v[200:203], v[128:131], v[64:79]
    buffer_load_dwordx4 v[184:187], v30, s[20:23], s75 offen sc1
    v_mfma_f32_32x32x16_bf16 v[80:95], v[204:207], v[128:131], v[80:95]
    v_mfma_f32_32x32x16_bf16 v[96:111], v[200:203], v[132:135], v[96:111]
    buffer_load_dwordx4 v[188:191], v31, s[20:23], s75 offen sc1
    v_mfma_f32_32x32x16_bf16 v[112:127], v[204:207], v[132:135], v[112:127]
    s_waitcnt vmcnt(12)
    v_mfma_f32_32x32x16_bf16 v[64:79], v[192:195], v[136:139], v[64:79]
    ds_read_b64_tr_b16 v[32:33], v5 offset:32768
    ds_read_b64_tr_b16 v[34:35], v5 offset:33792
    buffer_load_dwordx4 v[128:131], v30, s[20:23], s76 offen sc1
    v_mfma_f32_32x32x16_bf16 v[80:95], v[196:199], v[136:139], v[80:95]
    ds_read_b64_tr_b16 v[36:37], v6 offset:32768
    ds_read_b64_tr_b16 v[38:39], v6 offset:33792
    v_mfma_f32_32x32x16_bf16 v[96:111], v[192:195], v[140:143], v[96:111]
    buffer_load_dwordx4 v[132:135], v31, s[20:23], s76 offen sc1
    v_mfma_f32_32x32x16_bf16 v[112:127], v[196:199], v[140:143], v[112:127]
    s_waitcnt vmcnt(12) lgkmcnt(0)
    v_mfma_f32_32x32x16_bf16 v[64:79], v[32:35], v[144:147], v[64:79]
    ds_read_b64_tr_b16 v[40:41], v5 offset:40960
    ds_read_b64_tr_b16 v[42:43], v5 offset:41984
    buffer_load_dwordx4 v[136:139], v30, s[20:23], s77 offen sc1
    v_mfma_f32_32x32x16_bf16 v[80:95], v[36:39], v[144:147], v[80:95]
    ds_read_b64_tr_b16 v[44:45], v6 offset:40960
    ds_read_b64_tr_b16 v[46:47], v6 offset:41984
    v_mfma_f32_32x32x16_bf16 v[96:111], v[32:35], v[148:151], v[96:111]
    buffer_load_dwordx4 v[140:143], v31, s[20:23], s77 offen sc1
    v_mfma_f32_32x32x16_bf16 v[112:127], v[36:39], v[148:151], v[112:127]
    s_waitcnt vmcnt(12) lgkmcnt(0)
    v_mfma_f32_32x32x16_bf16 v[64:79], v[40:43], v[152:155], v[64:79]
    ds_read_b64_tr_b16 v[32:33], v5 offset:0
    ds_read_b64_tr_b16 v[34:35], v5 offset:1024
    buffer_load_dwordx4 v[144:147], v30, s[20:23], s78 offen sc1
    v_mfma_f32_32x32x16_bf16 v[80:95], v[44:47], v[152:155], v[80:95]
    ds_read_b64_tr_b16 v[36:37], v6 offset:0
    ds_read_b64_tr_b16 v[38:39], v6 offset:1024
    v_mfma_f32_32x32x16_bf16 v[96:111], v[40:43], v[156:159], v[96:111]
    buffer_load_dwordx4 v[148:151], v31, s[20:23], s78 offen sc1
    v_mfma_f32_32x32x16_bf16 v[112:127], v[44:47], v[156:159], v[112:127]
    s_waitcnt vmcnt(12) lgkmcnt(0)
    v_mfma_f32_32x32x16_bf16 v[64:79], v[32:35], v[160:163], v[64:79]
    ds_read_b64_tr_b16 v[40:41], v5 offset:8192
    ds_read_b64_tr_b16 v[42:43], v5 offset:9216
    buffer_load_dwordx4 v[152:155], v30, s[20:23], s79 offen sc1
    v_mfma_f32_32x32x16_bf16 v[80:95], v[36:39], v[160:163], v[80:95]
    ds_read_b64_tr_b16 v[44:45], v6 offset:8192
    ds_read_b64_tr_b16 v[46:47], v6 offset:9216
    v_mfma_f32_32x32x16_bf16 v[96:111], v[32:35], v[164:167], v[96:111]
    buffer_load_dwordx4 v[156:159], v31, s[20:23], s79 offen sc1
    v_mfma_f32_32x32x16_bf16 v[112:127], v[36:39], v[164:167], v[112:127]
    s_waitcnt vmcnt(12) lgkmcnt(0)
    v_mfma_f32_32x32x16_bf16 v[64:79], v[40:43], v[168:171], v[64:79]
    ds_read_b64_tr_b16 v[32:33], v5 offset:16384
    ds_read_b64_tr_b16 v[34:35], v5 offset:17408
    v_mfma_f32_32x32x16_bf16 v[80:95], v[44:47], v[168:171], v[80:95]
    ds_read_b64_tr_b16 v[36:37], v6 offset:16384
    ds_read_b64_tr_b16 v[38:39], v6 offset:17408
    v_mfma_f32_32x32x16_bf16 v[96:111], v[40:43], v[172:175], v[96:111]
    v_mfma_f32_32x32x16_bf16 v[112:127], v[44:47], v[172:175], v[112:127]
    s_waitcnt vmcnt(10) lgkmcnt(0)
    v_mfma_f32_32x32x16_bf16 v[64:79], v[32:35], v[176:179], v[64:79]
    ds_read_b64_tr_b16 v[40:41], v5 offset:24576
    ds_read_b64_tr_b16 v[42:43], v5 offset:25600
    v_mfma_f32_32x32x16_bf16 v[80:95], v[36:39], v[176:179], v[80:95]
    ds_read_b64_tr_b16 v[44:45], v6 offset:24576
    ds_read_b64_tr_b16 v[46:47], v6 offset:25600
    v_mfma_f32_32x32x16_bf16 v[96:111], v[32:35], v[180:183], v[96:111]
    v_mfma_f32_32x32x16_bf16 v[112:127], v[36:39], v[180:183], v[112:127]
    v_lshrrev_b32 v10, 5, v1
    v_and_b32 v11, 7, v1
    v_xor_b32 v10, v10, v11
    v_lshlrev_b32 v16, 8, v11
    v_lshl_add_u32 v16, v10, 4, v16
    v_add_u32 v16, s49, v16
    v_bfe_u32 v10, v1, 3, 2
    v_mov_b32 v11, 137216
    v_mov_b32 v20, 90112
    v_cmp_eq_u32 vcc, 2, v10
    s_nop 1
    v_cndmask_b32 v11, v11, v20, vcc
    v_lshlrev_b32 v21, 13, v10
    v_add_u32 v20, 32768, v21
    v_cmp_gt_u32 vcc, 2, v10
    s_nop 1
    v_cndmask_b32 v11, v11, v20, vcc
    v_add_u32 v20, v11, v16
    v_add_u32 v16, v21, v16
    v_xor_b32 v17, 32, v16
    v_xor_b32 v21, 32, v20
    v_xor_b32 v18, 64, v16
    v_xor_b32 v22, 64, v20
    v_xor_b32 v19, 96, v16
    v_xor_b32 v23, 96, v20
    s_waitcnt vmcnt(8) lgkmcnt(0)
    v_mfma_f32_32x32x16_bf16 v[64:79], v[40:43], v[184:187], v[64:79]
    ds_read_b64_tr_b16 v[32:33], v12 offset:0
    ds_read_b64_tr_b16 v[34:35], v12 offset:1024
    v_mfma_f32_32x32x16_bf16 v[80:95], v[44:47], v[184:187], v[80:95]
    ds_read_b64_tr_b16 v[36:37], v13 offset:0
    ds_read_b64_tr_b16 v[38:39], v13 offset:1024
    v_mfma_f32_32x32x16_bf16 v[96:111], v[40:43], v[188:191], v[96:111]
    v_mfma_f32_32x32x16_bf16 v[112:127], v[44:47], v[188:191], v[112:127]
    s_waitcnt vmcnt(6) lgkmcnt(0)
    v_mfma_f32_32x32x16_bf16 v[64:79], v[32:35], v[128:131], v[64:79]
    ds_read_b64_tr_b16 v[40:41], v12 offset:47104
    ds_read_b64_tr_b16 v[42:43], v12 offset:48128
    v_mfma_f32_32x32x16_bf16 v[80:95], v[36:39], v[128:131], v[80:95]
    ds_read_b64_tr_b16 v[44:45], v13 offset:47104
    ds_read_b64_tr_b16 v[46:47], v13 offset:48128
    v_mfma_f32_32x32x16_bf16 v[96:111], v[32:35], v[132:135], v[96:111]
    v_mfma_f32_32x32x16_bf16 v[112:127], v[36:39], v[132:135], v[112:127]
    s_waitcnt vmcnt(4) lgkmcnt(0)
    v_mfma_f32_32x32x16_bf16 v[64:79], v[40:43], v[136:139], v[64:79]
    ds_read_b64_tr_b16 v[32:33], v12 offset:55296
    ds_read_b64_tr_b16 v[34:35], v12 offset:56320
    v_mfma_f32_32x32x16_bf16 v[80:95], v[44:47], v[136:139], v[80:95]
    ds_read_b64_tr_b16 v[36:37], v13 offset:55296
    ds_read_b64_tr_b16 v[38:39], v13 offset:56320
    v_mfma_f32_32x32x16_bf16 v[96:111], v[40:43], v[140:143], v[96:111]
    v_mfma_f32_32x32x16_bf16 v[112:127], v[44:47], v[140:143], v[112:127]
    s_waitcnt vmcnt(2) lgkmcnt(0)
    v_mfma_f32_32x32x16_bf16 v[64:79], v[32:35], v[144:147], v[64:79]
    ds_read_b64_tr_b16 v[40:41], v12 offset:63488
    ds_read_b64_tr_b16 v[42:43], v12 offset:64512
    v_mfma_f32_32x32x16_bf16 v[80:95], v[36:39], v[144:147], v[80:95]
    ds_read_b64_tr_b16 v[44:45], v13 offset:63488
    ds_read_b64_tr_b16 v[46:47], v13 offset:64512
    v_mfma_f32_32x32x16_bf16 v[96:111], v[32:35], v[148:151], v[96:111]
    v_mfma_f32_32x32x16_bf16 v[112:127], v[36:39], v[148:151], v[112:127]
    s_waitcnt vmcnt(0) lgkmcnt(0)
    v_mfma_f32_32x32x16_bf16 v[64:79], v[40:43], v[152:155], v[64:79]
    v_mfma_f32_32x32x16_bf16 v[80:95], v[44:47], v[152:155], v[80:95]
    v_mfma_f32_32x32x16_bf16 v[96:111], v[40:43], v[156:159], v[96:111]
    v_mfma_f32_32x32x16_bf16 v[112:127], v[44:47], v[156:159], v[112:127]
    s_nop 8
    ds_write_b128 v16, v[64:67] offset:0
    ds_write_b128 v17, v[68:71] offset:0
    ds_write_b128 v18, v[72:75] offset:0
    ds_write_b128 v19, v[76:79] offset:0
    ds_write_b128 v16, v[80:83] offset:128
    ds_write_b128 v17, v[84:87] offset:128
    ds_write_b128 v18, v[88:91] offset:128
    ds_write_b128 v19, v[92:95] offset:128
    ds_write_b128 v20, v[96:99] offset:0
    ds_write_b128 v21, v[100:103] offset:0
    ds_write_b128 v22, v[104:107] offset:0
    ds_write_b128 v23, v[108:111] offset:0
    ds_write_b128 v20, v[112:115] offset:128
    ds_write_b128 v21, v[116:119] offset:128
    ds_write_b128 v22, v[120:123] offset:128
    ds_write_b128 v23, v[124:127] offset:128
    s_mov_b32 s32, s16
    s_and_b32 s33, s17, 0xffff
    s_mov_b32 s34, 1835008
    s_mov_b32 s35, 0x20000
    v_lshrrev_b32 v10, 3, v1
    v_and_b32 v11, 7, v1
    v_lshlrev_b32 v11, 1, v11
    v_xor_b32 v11, v11, v10
    v_lshlrev_b32 v10, 8, v10
    v_lshl_add_u32 v10, v11, 4, v10
    s_lshl_b32 s3, s10, 13
    s_cmp_eq_u32 s10, 6
    s_cselect_b32 s3, 90112, s3
    s_cmp_eq_u32 s10, 7
    s_cselect_b32 s3, 137216, s3
    v_add_u32 v12, s3, v10
    v_xor_b32 v13, 16, v12
    s_lshl_b32 s3, s10, 11
    s_add_u32 s3, s3, 49152
    v_add_u32 v14, s3, v10
    v_xor_b32 v15, 16, v14
    s_mov_b32 s52, 0xbfb8aa3b
    s_mov_b32 s53, s52
    v_lshlrev_b32 v200, 16, v56
    v_and_b32 v201, 0xffff0000, v56
    v_lshlrev_b32 v202, 16, v57
    v_and_b32 v203, 0xffff0000, v57
    v_lshlrev_b32 v204, 16, v58
    v_and_b32 v205, 0xffff0000, v58
    v_lshlrev_b32 v206, 16, v59
    v_and_b32 v207, 0xffff0000, v59
    s_waitcnt lgkmcnt(0)
    s_barrier
    ds_read_b128 v[144:147], v12 offset:0
    ds_read_b128 v[148:151], v13 offset:0
    ds_read_b128 v[152:155], v12 offset:2048
    ds_read_b128 v[156:159], v13 offset:2048
    ds_read_b128 v[160:163], v12 offset:4096
    ds_read_b128 v[164:167], v13 offset:4096
    ds_read_b128 v[168:171], v12 offset:6144
    ds_read_b128 v[172:175], v13 offset:6144
    ds_read_b128 v[176:179], v14 offset:0
    ds_read_b128 v[180:183], v15 offset:0
    ds_read_b128 v[184:187], v14 offset:16384
    ds_read_b128 v[188:191], v15 offset:16384
    s_waitcnt lgkmcnt(8)
    v_pk_add_f32 v[144:145], v[144:145], v[152:153]
    v_pk_add_f32 v[146:147], v[146:147], v[154:155]
    v_pk_add_f32 v[148:149], v[148:149], v[156:157]
    v_pk_add_f32 v[150:151], v[150:151], v[158:159]
    s_waitcnt lgkmcnt(4)
    v_pk_add_f32 v[160:161], v[160:161], v[168:169]
    v_pk_add_f32 v[162:163], v[162:163], v[170:171]
    v_pk_add_f32 v[164:165], v[164:165], v[172:173]
    v_pk_add_f32 v[166:167], v[166:167], v[174:175]
    v_pk_add_f32 v[144:145], v[144:145], v[160:161]
    v_pk_add_f32 v[146:147], v[146:147], v[162:163]
    v_pk_add_f32 v[148:149], v[148:149], v[164:165]
    v_pk_add_f32 v[150:151], v[150:151], v[166:167]
    v_pk_mul_f32 v[192:193], v[144:145], s[52:53]
    v_pk_mul_f32 v[194:195], v[146:147], s[52:53]
    v_pk_mul_f32 v[196:197], v[148:149], s[52:53]
    v_pk_mul_f32 v[198:199], v[150:151], s[52:53]
    v_exp_f32 v192, v192
    v_exp_f32 v193, v193
    v_exp_f32 v194, v194
    v_exp_f32 v195, v195
    v_exp_f32 v196, v196
    v_exp_f32 v197, v197
    v_exp_f32 v198, v198
    v_exp_f32 v199, v199
    s_waitcnt lgkmcnt(0)
    v_pk_add_f32 v[176:177], v[176:177], v[184:185]
    v_pk_add_f32 v[178:179], v[178:179], v[186:187]
    v_pk_add_f32 v[180:181], v[180:181], v[188:189]
    v_pk_add_f32 v[182:183], v[182:183], v[190:191]
    v_pk_add_f32 v[192:193], v[192:193], 1.0 op_sel_hi:[1,0]
    v_pk_add_f32 v[194:195], v[194:195], 1.0 op_sel_hi:[1,0]
    v_pk_add_f32 v[196:197], v[196:197], 1.0 op_sel_hi:[1,0]
    v_pk_add_f32 v[198:199], v[198:199], 1.0 op_sel_hi:[1,0]
    v_rcp_f32 v192, v192
    v_rcp_f32 v193, v193
    v_rcp_f32 v194, v194
    v_rcp_f32 v195, v195
    v_rcp_f32 v196, v196
    v_rcp_f32 v197, v197
    v_rcp_f32 v198, v198
    v_rcp_f32 v199, v199
    v_pk_mul_f32 v[176:177], v[176:177], v[144:145]
    v_pk_mul_f32 v[178:179], v[178:179], v[146:147]
    v_pk_mul_f32 v[180:181], v[180:181], v[148:149]
    v_pk_mul_f32 v[182:183], v[182:183], v[150:151]
    v_pk_fma_f32 v[144:145], v[176:177], v[192:193], v[200:201]
    v_pk_fma_f32 v[146:147], v[178:179], v[194:195], v[202:203]
    v_pk_fma_f32 v[148:149], v[180:181], v[196:197], v[204:205]
    v_pk_fma_f32 v[150:151], v[182:183], v[198:199], v[206:207]
    v_cvt_pk_bf16_f32 v56, v144, v145
    v_cvt_pk_bf16_f32 v57, v146, v147
    v_cvt_pk_bf16_f32 v58, v148, v149
    v_cvt_pk_bf16_f32 v59, v150, v151
    buffer_store_dwordx4 v[56:59], v61, s[32:35], 0 offen sc1
    s_endpgm
L_B:
    s_waitcnt lgkmcnt(0)
    s_mov_b32 s10, s44
    s_mov_b32 s11, s45
    s_and_b32 s21, s21, 0xffff
    s_mov_b32 s22, 20971520
    s_mov_b32 s23, 0x20000
    s_mov_b32 s24, s4
    s_and_b32 s25, s5, 0xffff
    s_sub_u32 s28, s6, 1024
    s_subb_u32 s29, s7, 0
    s_and_b32 s29, s29, 0xffff
    s_setprio 2
    s_lshl_b32 s3, s38, 8
    v_mul_u32_u24 v30, 3584, v9
    v_add3_u32 v30, v30, v10, s3
    v_add_u32 v31, 27648, v30
    s_lshl_b32 s49, s36, 11
    s_add_u32 s50, s39, 0
    s_sub_u32 s46, s50, 7
    s_min_u32 s50, s50, s46
    s_add_u32 s51, s39, 1
    s_sub_u32 s46, s51, 7
    s_min_u32 s51, s51, s46
    s_add_u32 s52, s39, 2
    s_sub_u32 s46, s52, 7
    s_min_u32 s52, s52, s46
    s_add_u32 s53, s39, 3
    s_sub_u32 s46, s53, 7
    s_min_u32 s53, s53, s46
    s_add_u32 s54, s39, 4
    s_sub_u32 s46, s54, 7
    s_min_u32 s54, s54, s46
    s_add_u32 s55, s39, 5
    s_sub_u32 s46, s55, 7
    s_min_u32 s55, s55, s46
    s_add_u32 s56, s39, 6
    s_sub_u32 s46, s56, 7
    s_min_u32 s56, s56, s46
    s_mov_b32 s32, s12
    s_and_b32 s33, s13, 0xffff
    s_mov_b32 s34, 1605632
    s_mov_b32 s35, 0x20000
    v_mov_b32 v8, 0
    v_mov_b32 v7, 163712
    v_and_b32 v10, 31, v1
    v_lshlrev_b32 v12, 7, v10
    v_bfe_u32 v10, v1, 1, 3
    v_lshrrev_b32 v11, 5, v1
    v_xor_b32 v10, v10, v11
    v_lshl_add_u32 v12, v10, 4, v12
    v_add_u32 v12, s48, v12
    v_xor_b32 v13, 32, v12
    v_xor_b32 v14, 64, v12
    v_xor_b32 v15, 96, v12
    v_lshlrev_b32 v9, 4, v11
    v_add_u32 v9, 161792, v9
    v_lshrrev_b32 v24, 5, v1
    v_bfe_u32 v10, v1, 2, 2
    v_lshl_add_u32 v24, v24, 3, v10
    v_lshlrev_b32 v24, 7, v24
    v_bfe_u32 v10, v1, 3, 1
    v_lshl_add_u32 v24, v10, 6, v24
    v_bfe_u32 v10, v1, 4, 1
    v_lshl_add_u32 v24, v10, 5, v24
    v_and_b32 v10, 3, v1
    v_lshl_add_u32 v24, v10, 3, v24
    v_lshl_add_u32 v27, v11, 10, v24
    s_and_b32 s3, s38, 1
    s_add_u32 s44, s3, 2
    s_and_b32 s45, s44, 1
    s_lshl_b32 s45, s45, 6
    s_lshr_b32 s44, s44, 1
    s_lshl_b32 s44, s44, 10
    s_add_u32 s44, s44, 16384
    v_xor_b32 v16, s45, v27
    v_add_u32 v16, s44, v16
    s_min_u32 s44, s36, 2
    s_add_u32 s44, s44, s3
    s_and_b32 s45, s44, 1
    s_lshl_b32 s45, s45, 6
    s_lshr_b32 s44, s44, 1
    s_lshl_b32 s44, s44, 10
    s_add_u32 s44, s44, 16384
    v_xor_b32 v17, s45, v27
    v_add_u32 v17, s44, v17
    v_and_b32 v10, 15, v1
    v_bfe_u32 v11, v1, 4, 1
    v_cmp_eq_u32 vcc, v10, v11
    v_mov_b32 v10, 0x3f803f80
    s_nop 0
    v_cndmask_b32 v56, 0, v10, vcc
    v_cndmask_b32 v57, 0, v10, vcc
    v_cndmask_b32 v58, 0, v10, vcc
    v_cndmask_b32 v59, 0, v10, vcc
    s_lshl2_add_u32 s3, s37, s36
    s_mul_i32 s57, s3, 84
    s_mul_i32 s44, s38, 6
    s_add_u32 s57, s57, s44
    s_add_u32 s57, s57, 4
    s_lshl_b32 s57, s57, 10
    s_mul_i32 s58, s3, 112
    s_lshl3_add_u32 s58, s38, s58
    s_lshl_b32 s58, s58, 10
    s_add_u32 s58, s58, 6291456
    s_mul_i32 s59, s3, 14
    s_add_u32 s59, s59, s38
    s_lshl_b32 s59, s59, 8
    s_add_u32 s59, s59, 18874496
    s_mov_b32 s60, s18
    s_and_b32 s61, s19, 0xffff
    s_mov_b32 s62, 256
    s_mov_b32 s63, 0x20000
    s_mul_i32 s3, s40, 7
    s_lshr_b32 s82, s3, 2
    s_and_b32 s83, s3, 3
    s_lshl2_add_u32 s84, s41, s36
    s_mul_i32 s3, s36, 3
    s_lshl2_add_u32 s3, s41, s3
    s_sub_u32 s85, s3, 8
    s_and_b32 s86, s36, 1
    s_lshr_b32 s87, s36, 1
    s_lshl1_add_u32 s88, s42, s87
    v_min_u32 v10, 13, v1
    v_lshrrev_b32 v26, 2, v10
    v_add_u32 v26, s85, v26
    v_max_i32 v26, 0, v26
    v_bfe_u32 v27, v10, 1, 1
    v_mul_u32_u24 v27, 28, v27
    v_add_u32 v27, 28, v27
    v_cmp_le_u32 vcc, 12, v10
    v_mov_b32 v28, s84
    s_nop 0
    v_cndmask_b32 v26, v26, v28, vcc
    v_cndmask_b32 v27, v27, v8, vcc
    v_and_b32 v28, 1, v10
    v_lshl_add_u32 v27, v28, 1, v27
    v_add_u32 v27, s82, v27
    v_lshrrev_b32 v27, 1, v27
    v_min_u32 v27, 41, v27
    v_mul_u32_u24 v28, 43, v27
    v_lshrrev_b32 v28, 7, v28
    v_mul_u32_u24 v29, 3, v28
    v_sub_u32 v29, v27, v29
    v_lshrrev_b32 v29, 1, v29
    v_mul_u32_u24 v26, 14, v26
    v_add_lshl_u32 v26, v26, v28, 1
    v_add_lshl_u32 v5, v26, v29, 7
    v_add_u32 v5, 18874368, v5
    v_lshrrev_b32 v26, 5, v1
    v_add_u32 v26, 2, v26
    v_add_u32 v27, 1073741824, v2
    v_cmp_gt_u32 vcc, s83, v26
    s_nop 1
    v_cndmask_b32 v3, v2, v27, vcc
    v_cmp_lt_u32 vcc, s83, v26
    s_nop 1
    v_cndmask_b32 v4, v2, v27, vcc
    s_add_u32 m0, s48, 32768
    s_lshl_b32 s3, s51, 7
    buffer_load_dwordx4 v240, s[24:27], s3 offen offset:0 lds
    buffer_load_dwordx4 v241, s[24:27], s3 offen offset:1024 lds
    buffer_load_dwordx4 v242, s[24:27], s3 offen offset:2048 lds
    buffer_load_dwordx4 v243, s[24:27], s3 offen offset:3072 lds
    s_add_u32 m0, s48, 49152
    s_mul_i32 s3, s51, 172032
    buffer_load_dwordx4 v244, s[28:31], s3 offen offset:0 lds
    buffer_load_dwordx4 v245, s[28:31], s3 offen offset:1024 lds
    buffer_load_dwordx4 v246, s[28:31], s3 offen offset:2048 lds
    buffer_load_dwordx4 v247, s[28:31], s3 offen offset:3072 lds
    v_mov_b32 v112, 0
    v_mov_b32 v113, 0
    v_mov_b32 v114, 0
    v_mov_b32 v115, 0
    v_mov_b32 v116, 0x3f803f80
    s_waitcnt lgkmcnt(0)
    s_barrier
    ds_read_b128 v[128:131], v12 offset:0
    ds_read_b64_tr_b16 v[32:33], v16 offset:0
    ds_read_b64_tr_b16 v[34:35], v16 offset:512
    ds_read_b64_tr_b16 v[36:37], v17 offset:0
    ds_read_b64_tr_b16 v[38:39], v17 offset:512
    ds_read_b128 v[132:135], v13 offset:0
    ds_read_b64_tr_b16 v[40:41], v16 offset:4096
    ds_read_b64_tr_b16 v[42:43], v16 offset:4608
    ds_read_b64_tr_b16 v[44:45], v17 offset:4096
    ds_read_b64_tr_b16 v[46:47], v17 offset:4608
    ds_read_b128 v[136:139], v14 offset:0
    ds_read_b128 v[140:143], v15 offset:0
    s_waitcnt lgkmcnt(7)
    v_mfma_f32_32x32x16_bf16 v[64:79], v[32:35], v[128:131], 0
    ds_read_b64_tr_b16 v[48:49], v16 offset:8192
    ds_read_b64_tr_b16 v[50:51], v16 offset:8704
    ds_read_b64_tr_b16 v[52:53], v17 offset:8192
    ds_read_b64_tr_b16 v[54:55], v17 offset:8704
    v_mfma_f32_16x16x32_bf16 v[80:83], v[36:39], v[56:59], 0
    s_add_u32 m0, s48, 81920
    s_mul_i32 s3, s52, 172032
    buffer_load_dwordx4 v244, s[28:31], s3 offen offset:0 lds
    buffer_load_dwordx4 v245, s[28:31], s3 offen offset:1024 lds
    s_waitcnt lgkmcnt(6)
    v_mfma_f32_32x32x16_bf16 v[64:79], v[40:43], v[132:135], v[64:79]
    ds_read_b64_tr_b16 v[32:33], v16 offset:12288
    ds_read_b64_tr_b16 v[34:35], v16 offset:12800
    ds_read_b64_tr_b16 v[36:37], v17 offset:12288
    v_mfma_f32_16x16x32_bf16 v[80:83], v[44:47], v[56:59], v[80:83]
    ds_read_b64_tr_b16 v[38:39], v17 offset:12800
    buffer_load_dwordx4 v246, s[28:31], s3 offen offset:2048 lds
    buffer_load_dwordx4 v247, s[28:31], s3 offen offset:3072 lds
    s_waitcnt lgkmcnt(8)
    v_dot2c_f32_bf16 v112, v128, v116
    v_dot2c_f32_bf16 v114, v128, v128
    v_dot2c_f32_bf16 v113, v129, v116
    v_dot2c_f32_bf16 v115, v129, v129
    v_dot2c_f32_bf16 v112, v130, v116
    v_dot2c_f32_bf16 v114, v130, v130
    v_dot2c_f32_bf16 v113, v131, v116
    v_dot2c_f32_bf16 v115, v131, v131
    v_dot2c_f32_bf16 v112, v132, v116
    v_dot2c_f32_bf16 v114, v132, v132
    v_dot2c_f32_bf16 v113, v133, v116
    v_dot2c_f32_bf16 v115, v133, v133
    v_dot2c_f32_bf16 v112, v134, v116
    v_dot2c_f32_bf16 v114, v134, v134
    v_dot2c_f32_bf16 v113, v135, v116
    v_dot2c_f32_bf16 v115, v135, v135
    v_dot2c_f32_bf16 v112, v136, v116
    v_dot2c_f32_bf16 v114, v136, v136
    v_dot2c_f32_bf16 v113, v137, v116
    v_dot2c_f32_bf16 v115, v137, v137
    v_dot2c_f32_bf16 v112, v138, v116
    v_dot2c_f32_bf16 v114, v138, v138
    v_dot2c_f32_bf16 v113, v139, v116
    v_dot2c_f32_bf16 v115, v139, v139
    v_dot2c_f32_bf16 v112, v140, v116
    v_dot2c_f32_bf16 v114, v140, v140
    v_dot2c_f32_bf16 v113, v141, v116
    v_dot2c_f32_bf16 v115, v141, v141
    v_dot2c_f32_bf16 v112, v142, v116
    v_dot2c_f32_bf16 v114, v142, v142
    v_dot2c_f32_bf16 v113, v143, v116
    v_dot2c_f32_bf16 v115, v143, v143
    s_waitcnt vmcnt(4) lgkmcnt(0)
    s_barrier
    v_mfma_f32_32x32x16_bf16 v[64:79], v[48:51], v[136:139], v[64:79]
    ds_read_b128 v[144:147], v12 offset:32768
    ds_read_b128 v[148:151], v13 offset:32768
    ds_read_b64_tr_b16 v[40:41], v16 offset:32768
    ds_read_b64_tr_b16 v[42:43], v16 offset:33280
    ds_read_b64_tr_b16 v[44:45], v17 offset:32768
    v_mfma_f32_16x16x32_bf16 v[80:83], v[52:55], v[56:59], v[80:83]
    ds_read_b64_tr_b16 v[46:47], v17 offset:33280
    s_add_u32 m0, s48, 16384
    s_mul_i32 s3, s53, 172032
    buffer_load_dwordx4 v244, s[28:31], s3 offen offset:0 lds
    v_mfma_f32_32x32x16_bf16 v[64:79], v[32:35], v[140:143], v[64:79]
    ds_read_b128 v[152:155], v14 offset:32768
    ds_read_b128 v[156:159], v15 offset:32768
    ds_read_b64_tr_b16 v[48:49], v16 offset:36864
    ds_read_b64_tr_b16 v[50:51], v16 offset:37376
    v_mfma_f32_16x16x32_bf16 v[80:83], v[36:39], v[56:59], v[80:83]
    ds_read_b64_tr_b16 v[52:53], v17 offset:36864
    ds_read_b64_tr_b16 v[54:55], v17 offset:37376
    buffer_load_dwordx4 v245, s[28:31], s3 offen offset:1024 lds
    s_waitcnt lgkmcnt(6)
    v_mfma_f32_32x32x16_bf16 v[64:79], v[40:43], v[144:147], v[64:79]
    ds_read_b64_tr_b16 v[32:33], v16 offset:40960
    ds_read_b64_tr_b16 v[34:35], v16 offset:41472
    ds_read_b64_tr_b16 v[36:37], v17 offset:40960
    v_mfma_f32_16x16x32_bf16 v[80:83], v[44:47], v[56:59], v[80:83]
    ds_read_b64_tr_b16 v[38:39], v17 offset:41472
    buffer_load_dwordx4 v246, s[28:31], s3 offen offset:2048 lds
    s_waitcnt lgkmcnt(4)
    v_mfma_f32_32x32x16_bf16 v[64:79], v[48:51], v[148:151], v[64:79]
    ds_read_b64_tr_b16 v[40:41], v16 offset:45056
    ds_read_b64_tr_b16 v[42:43], v16 offset:45568
    ds_read_b64_tr_b16 v[44:45], v17 offset:45056
    v_mfma_f32_16x16x32_bf16 v[80:83], v[52:55], v[56:59], v[80:83]
    ds_read_b64_tr_b16 v[46:47], v17 offset:45568
    buffer_load_dwordx4 v247, s[28:31], s3 offen offset:3072 lds
    v_dot2c_f32_bf16 v112, v144, v116
    v_dot2c_f32_bf16 v114, v144, v144
    v_dot2c_f32_bf16 v113, v145, v116
    v_dot2c_f32_bf16 v115, v145, v145
    v_dot2c_f32_bf16 v112, v146, v116
    v_dot2c_f32_bf16 v114, v146, v146
    v_dot2c_f32_bf16 v113, v147, v116
    v_dot2c_f32_bf16 v115, v147, v147
    v_dot2c_f32_bf16 v112, v148, v116
    v_dot2c_f32_bf16 v114, v148, v148
    v_dot2c_f32_bf16 v113, v149, v116
    v_dot2c_f32_bf16 v115, v149, v149
    v_dot2c_f32_bf16 v112, v150, v116
    v_dot2c_f32_bf16 v114, v150, v150
    v_dot2c_f32_bf16 v113, v151, v116
    v_dot2c_f32_bf16 v115, v151, v151
    v_dot2c_f32_bf16 v112, v152, v116
    v_dot2c_f32_bf16 v114, v152, v152
    v_dot2c_f32_bf16 v113, v153, v116
    v_dot2c_f32_bf16 v115, v153, v153
    v_dot2c_f32_bf16 v112, v154, v116
    v_dot2c_f32_bf16 v114, v154, v154
    v_dot2c_f32_bf16 v113, v155, v116
    v_dot2c_f32_bf16 v115, v155, v155
    v_dot2c_f32_bf16 v112, v156, v116
    v_dot2c_f32_bf16 v114, v156, v156
    v_dot2c_f32_bf16 v113, v157, v116
    v_dot2c_f32_bf16 v115, v157, v157
    v_dot2c_f32_bf16 v112, v158, v116
    v_dot2c_f32_bf16 v114, v158, v158
    v_dot2c_f32_bf16 v113, v159, v116
    v_dot2c_f32_bf16 v115, v159, v159
    s_waitcnt vmcnt(4) lgkmcnt(0)
    s_barrier
    v_add_u32 v12, 65536, v12
    v_add_u32 v13, 65536, v13
    v_add_u32 v14, 65536, v14
    v_add_u32 v15, 65536, v15
    v_add_u32 v16, 65536, v16
    v_add_u32 v17, 65536, v17
    v_mfma_f32_32x32x16_bf16 v[64:79], v[32:35], v[152:155], v[64:79]
    ds_read_b128 v[160:163], v12 offset:0
    ds_read_b128 v[164:167], v13 offset:0
    ds_read_b64_tr_b16 v[48:49], v16 offset:0
    ds_read_b64_tr_b16 v[50:51], v16 offset:512
    ds_read_b64_tr_b16 v[52:53], v17 offset:0
    v_mfma_f32_16x16x32_bf16 v[80:83], v[36:39], v[56:59], v[80:83]
    ds_read_b64_tr_b16 v[54:55], v17 offset:512
    s_add_u32 m0, s48, 49152
    s_mul_i32 s3, s54, 172032
    buffer_load_dwordx4 v244, s[28:31], s3 offen offset:0 lds
    v_mfma_f32_32x32x16_bf16 v[64:79], v[40:43], v[156:159], v[64:79]
    ds_read_b128 v[168:171], v14 offset:0
    ds_read_b128 v[172:175], v15 offset:0
    ds_read_b64_tr_b16 v[32:33], v16 offset:4096
    ds_read_b64_tr_b16 v[34:35], v16 offset:4608
    v_mfma_f32_16x16x32_bf16 v[80:83], v[44:47], v[56:59], v[80:83]
    ds_read_b64_tr_b16 v[36:37], v17 offset:4096
    ds_read_b64_tr_b16 v[38:39], v17 offset:4608
    buffer_load_dwordx4 v245, s[28:31], s3 offen offset:1024 lds
    s_waitcnt lgkmcnt(6)
    v_mfma_f32_32x32x16_bf16 v[64:79], v[48:51], v[160:163], v[64:79]
    ds_read_b64_tr_b16 v[40:41], v16 offset:8192
    ds_read_b64_tr_b16 v[42:43], v16 offset:8704
    ds_read_b64_tr_b16 v[44:45], v17 offset:8192
    v_mfma_f32_16x16x32_bf16 v[80:83], v[52:55], v[56:59], v[80:83]
    ds_read_b64_tr_b16 v[46:47], v17 offset:8704
    buffer_load_dwordx4 v246, s[28:31], s3 offen offset:2048 lds
    s_waitcnt lgkmcnt(4)
    v_mfma_f32_32x32x16_bf16 v[64:79], v[32:35], v[164:167], v[64:79]
    ds_read_b64_tr_b16 v[48:49], v16 offset:12288
    ds_read_b64_tr_b16 v[50:51], v16 offset:12800
    ds_read_b64_tr_b16 v[52:53], v17 offset:12288
    v_mfma_f32_16x16x32_bf16 v[80:83], v[36:39], v[56:59], v[80:83]
    ds_read_b64_tr_b16 v[54:55], v17 offset:12800
    buffer_load_dwordx4 v247, s[28:31], s3 offen offset:3072 lds
    v_dot2c_f32_bf16 v112, v160, v116
    v_dot2c_f32_bf16 v114, v160, v160
    v_dot2c_f32_bf16 v113, v161, v116
    v_dot2c_f32_bf16 v115, v161, v161
    v_dot2c_f32_bf16 v112, v162, v116
    v_dot2c_f32_bf16 v114, v162, v162
    v_dot2c_f32_bf16 v113, v163, v116
    v_dot2c_f32_bf16 v115, v163, v163
    v_dot2c_f32_bf16 v112, v164, v116
    v_dot2c_f32_bf16 v114, v164, v164
    v_dot2c_f32_bf16 v113, v165, v116
    v_dot2c_f32_bf16 v115, v165, v165
    v_dot2c_f32_bf16 v112, v166, v116
    v_dot2c_f32_bf16 v114, v166, v166
    v_dot2c_f32_bf16 v113, v167, v116
    v_dot2c_f32_bf16 v115, v167, v167
    v_dot2c_f32_bf16 v112, v168, v116
    v_dot2c_f32_bf16 v114, v168, v168
    v_dot2c_f32_bf16 v113, v169, v116
    v_dot2c_f32_bf16 v115, v169, v169
    v_dot2c_f32_bf16 v112, v170, v116
    v_dot2c_f32_bf16 v114, v170, v170
    v_dot2c_f32_bf16 v113, v171, v116
    v_dot2c_f32_bf16 v115, v171, v171
    v_dot2c_f32_bf16 v112, v172, v116
    v_dot2c_f32_bf16 v114, v172, v172
    v_dot2c_f32_bf16 v113, v173, v116
    v_dot2c_f32_bf16 v115, v173, v173
    v_dot2c_f32_bf16 v112, v174, v116
    v_dot2c_f32_bf16 v114, v174, v174
    v_dot2c_f32_bf16 v113, v175, v116
    v_dot2c_f32_bf16 v115, v175, v175
    s_waitcnt vmcnt(4) lgkmcnt(0)
    s_barrier
    v_subrev_u32 v12, 65536, v12
    v_subrev_u32 v13, 65536, v13
    v_subrev_u32 v14, 65536, v14
    v_subrev_u32 v15, 65536, v15
    v_subrev_u32 v16, 65536, v16
    v_subrev_u32 v17, 65536, v17
    v_mfma_f32_32x32x16_bf16 v[64:79], v[40:43], v[168:171], v[64:79]
    ds_read_b128 v[176:179], v12 offset:0
    ds_read_b128 v[180:183], v13 offset:0
    ds_read_b64_tr_b16 v[32:33], v16 offset:0
    ds_read_b64_tr_b16 v[34:35], v16 offset:512
    ds_read_b64_tr_b16 v[36:37], v17 offset:0
    v_mfma_f32_16x16x32_bf16 v[80:83], v[44:47], v[56:59], v[80:83]
    ds_read_b64_tr_b16 v[38:39], v17 offset:512
    s_add_u32 m0, s48, 81920
    s_mul_i32 s3, s55, 172032
    buffer_load_dwordx4 v244, s[28:31], s3 offen offset:0 lds
    v_mfma_f32_32x32x16_bf16 v[64:79], v[48:51], v[172:175], v[64:79]
    ds_read_b128 v[184:187], v14 offset:0
    ds_read_b128 v[188:191], v15 offset:0
    ds_read_b64_tr_b16 v[40:41], v16 offset:4096
    ds_read_b64_tr_b16 v[42:43], v16 offset:4608
    v_mfma_f32_16x16x32_bf16 v[80:83], v[52:55], v[56:59], v[80:83]
    ds_read_b64_tr_b16 v[44:45], v17 offset:4096
    ds_read_b64_tr_b16 v[46:47], v17 offset:4608
    buffer_load_dwordx4 v245, s[28:31], s3 offen offset:1024 lds
    s_waitcnt lgkmcnt(6)
    v_mfma_f32_32x32x16_bf16 v[64:79], v[32:35], v[176:179], v[64:79]
    ds_read_b64_tr_b16 v[48:49], v16 offset:8192
    ds_read_b64_tr_b16 v[50:51], v16 offset:8704
    ds_read_b64_tr_b16 v[52:53], v17 offset:8192
    v_mfma_f32_16x16x32_bf16 v[80:83], v[36:39], v[56:59], v[80:83]
    ds_read_b64_tr_b16 v[54:55], v17 offset:8704
    buffer_load_dwordx4 v246, s[28:31], s3 offen offset:2048 lds
    s_waitcnt lgkmcnt(4)
    v_mfma_f32_32x32x16_bf16 v[64:79], v[40:43], v[180:183], v[64:79]
    ds_read_b64_tr_b16 v[32:33], v16 offset:12288
    ds_read_b64_tr_b16 v[34:35], v16 offset:12800
    ds_read_b64_tr_b16 v[36:37], v17 offset:12288
    v_mfma_f32_16x16x32_bf16 v[80:83], v[44:47], v[56:59], v[80:83]
    ds_read_b64_tr_b16 v[38:39], v17 offset:12800
    buffer_load_dwordx4 v247, s[28:31], s3 offen offset:3072 lds
    v_dot2c_f32_bf16 v112, v176, v116
    v_dot2c_f32_bf16 v114, v176, v176
    v_dot2c_f32_bf16 v113, v177, v116
    v_dot2c_f32_bf16 v115, v177, v177
    v_dot2c_f32_bf16 v112, v178, v116
    v_dot2c_f32_bf16 v114, v178, v178
    v_dot2c_f32_bf16 v113, v179, v116
    v_dot2c_f32_bf16 v115, v179, v179
    v_dot2c_f32_bf16 v112, v180, v116
    v_dot2c_f32_bf16 v114, v180, v180
    v_dot2c_f32_bf16 v113, v181, v116
    v_dot2c_f32_bf16 v115, v181, v181
    v_dot2c_f32_bf16 v112, v182, v116
    v_dot2c_f32_bf16 v114, v182, v182
    v_dot2c_f32_bf16 v113, v183, v116
    v_dot2c_f32_bf16 v115, v183, v183
    v_dot2c_f32_bf16 v112, v184, v116
    v_dot2c_f32_bf16 v114, v184, v184
    v_dot2c_f32_bf16 v113, v185, v116
    v_dot2c_f32_bf16 v115, v185, v185
    v_dot2c_f32_bf16 v112, v186, v116
    v_dot2c_f32_bf16 v114, v186, v186
    v_dot2c_f32_bf16 v113, v187, v116
    v_dot2c_f32_bf16 v115, v187, v187
    v_dot2c_f32_bf16 v112, v188, v116
    v_dot2c_f32_bf16 v114, v188, v188
    v_dot2c_f32_bf16 v113, v189, v116
    v_dot2c_f32_bf16 v115, v189, v189
    v_dot2c_f32_bf16 v112, v190, v116
    v_dot2c_f32_bf16 v114, v190, v190
    v_dot2c_f32_bf16 v113, v191, v116
    v_dot2c_f32_bf16 v115, v191, v191
    s_waitcnt vmcnt(4) lgkmcnt(0)
    s_barrier
    v_mfma_f32_32x32x16_bf16 v[64:79], v[48:51], v[184:187], v[64:79]
    ds_read_b128 v[192:195], v12 offset:32768
    ds_read_b128 v[196:199], v13 offset:32768
    ds_read_b64_tr_b16 v[40:41], v16 offset:32768
    ds_read_b64_tr_b16 v[42:43], v16 offset:33280
    ds_read_b64_tr_b16 v[44:45], v17 offset:32768
    v_mfma_f32_16x16x32_bf16 v[80:83], v[52:55], v[56:59], v[80:83]
    ds_read_b64_tr_b16 v[46:47], v17 offset:33280
    s_add_u32 m0, s48, 16384
    s_mul_i32 s3, s56, 172032
    buffer_load_dwordx4 v244, s[28:31], s3 offen offset:0 lds
    v_mfma_f32_32x32x16_bf16 v[64:79], v[32:35], v[188:191], v[64:79]
    ds_read_b128 v[200:203], v14 offset:32768
    ds_read_b128 v[204:207], v15 offset:32768
    ds_read_b64_tr_b16 v[48:49], v16 offset:36864
    ds_read_b64_tr_b16 v[50:51], v16 offset:37376
    v_mfma_f32_16x16x32_bf16 v[80:83], v[36:39], v[56:59], v[80:83]
    ds_read_b64_tr_b16 v[52:53], v17 offset:36864
    ds_read_b64_tr_b16 v[54:55], v17 offset:37376
    buffer_load_dwordx4 v245, s[28:31], s3 offen offset:1024 lds
    s_waitcnt lgkmcnt(6)
    v_mfma_f32_32x32x16_bf16 v[64:79], v[40:43], v[192:195], v[64:79]
    ds_read_b64_tr_b16 v[32:33], v16 offset:40960
    ds_read_b64_tr_b16 v[34:35], v16 offset:41472
    ds_read_b64_tr_b16 v[36:37], v17 offset:40960
    v_mfma_f32_16x16x32_bf16 v[80:83], v[44:47], v[56:59], v[80:83]
    ds_read_b64_tr_b16 v[38:39], v17 offset:41472
    buffer_load_dwordx4 v246, s[28:31], s3 offen offset:2048 lds
    s_waitcnt lgkmcnt(4)
    v_mfma_f32_32x32x16_bf16 v[64:79], v[48:51], v[196:199], v[64:79]
    ds_read_b64_tr_b16 v[40:41], v16 offset:45056
    ds_read_b64_tr_b16 v[42:43], v16 offset:45568
    ds_read_b64_tr_b16 v[44:45], v17 offset:45056
    v_mfma_f32_16x16x32_bf16 v[80:83], v[52:55], v[56:59], v[80:83]
    ds_read_b64_tr_b16 v[46:47], v17 offset:45568
    buffer_load_dwordx4 v247, s[28:31], s3 offen offset:3072 lds
    v_dot2c_f32_bf16 v112, v192, v116
    v_dot2c_f32_bf16 v114, v192, v192
    v_dot2c_f32_bf16 v113, v193, v116
    v_dot2c_f32_bf16 v115, v193, v193
    v_dot2c_f32_bf16 v112, v194, v116
    v_dot2c_f32_bf16 v114, v194, v194
    v_dot2c_f32_bf16 v113, v195, v116
    v_dot2c_f32_bf16 v115, v195, v195
    v_dot2c_f32_bf16 v112, v196, v116
    v_dot2c_f32_bf16 v114, v196, v196
    v_dot2c_f32_bf16 v113, v197, v116
    v_dot2c_f32_bf16 v115, v197, v197
    v_dot2c_f32_bf16 v112, v198, v116
    v_dot2c_f32_bf16 v114, v198, v198
    v_dot2c_f32_bf16 v113, v199, v116
    v_dot2c_f32_bf16 v115, v199, v199
    v_dot2c_f32_bf16 v112, v200, v116
    v_dot2c_f32_bf16 v114, v200, v200
    v_dot2c_f32_bf16 v113, v201, v116
    v_dot2c_f32_bf16 v115, v201, v201
    v_dot2c_f32_bf16 v112, v202, v116
    v_dot2c_f32_bf16 v114, v202, v202
    v_dot2c_f32_bf16 v113, v203, v116
    v_dot2c_f32_bf16 v115, v203, v203
    v_dot2c_f32_bf16 v112, v204, v116
    v_dot2c_f32_bf16 v114, v204, v204
    v_dot2c_f32_bf16 v113, v205, v116
    v_dot2c_f32_bf16 v115, v205, v205
    v_dot2c_f32_bf16 v112, v206, v116
    v_dot2c_f32_bf16 v114, v206, v206
    v_dot2c_f32_bf16 v113, v207, v116
    v_dot2c_f32_bf16 v115, v207, v207
    s_waitcnt vmcnt(4) lgkmcnt(0)
    s_barrier
    v_add_u32 v12, 65536, v12
    v_add_u32 v13, 65536, v13
    v_add_u32 v14, 65536, v14
    v_add_u32 v15, 65536, v15
    v_add_u32 v16, 65536, v16
    v_add_u32 v17, 65536, v17
    v_mfma_f32_32x32x16_bf16 v[64:79], v[32:35], v[200:203], v[64:79]
    ds_read_b128 v[208:211], v12 offset:0
    ds_read_b128 v[212:215], v13 offset:0
    ds_read_b64_tr_b16 v[48:49], v16 offset:0
    ds_read_b64_tr_b16 v[50:51], v16 offset:512
    ds_read_b64_tr_b16 v[52:53], v17 offset:0
    v_mfma_f32_16x16x32_bf16 v[80:83], v[36:39], v[56:59], v[80:83]
    ds_read_b64_tr_b16 v[54:55], v17 offset:512
    s_add_u32 m0, s49, 139264
    s_mul_i32 s3, s55, 229376
    buffer_load_dwordx4 v30, s[32:35], s3 offen lds
    v_mfma_f32_32x32x16_bf16 v[64:79], v[40:43], v[204:207], v[64:79]
    ds_read_b128 v[216:219], v14 offset:0
    ds_read_b128 v[220:223], v15 offset:0
    ds_read_b64_tr_b16 v[32:33], v16 offset:4096
    ds_read_b64_tr_b16 v[34:35], v16 offset:4608
    v_mfma_f32_16x16x32_bf16 v[80:83], v[44:47], v[56:59], v[80:83]
    ds_read_b64_tr_b16 v[36:37], v17 offset:4096
    ds_read_b64_tr_b16 v[38:39], v17 offset:4608
    buffer_load_dwordx4 v31, s[32:35], s3 offen offset:1024 lds
    s_waitcnt lgkmcnt(6)
    v_mfma_f32_32x32x16_bf16 v[64:79], v[48:51], v[208:211], v[64:79]
    ds_read_b64_tr_b16 v[40:41], v16 offset:8192
    ds_read_b64_tr_b16 v[42:43], v16 offset:8704
    ds_read_b64_tr_b16 v[44:45], v17 offset:8192
    ds_read_b64_tr_b16 v[46:47], v17 offset:8704
    v_mfma_f32_16x16x32_bf16 v[80:83], v[52:55], v[56:59], v[80:83]
    s_add_u32 m0, s49, 40960
    s_mul_i32 s3, s51, 229376
    s_add_u32 s3, s3, 128
    buffer_load_dwordx4 v30, s[32:35], s3 offen lds
    s_waitcnt lgkmcnt(4)
    v_mfma_f32_32x32x16_bf16 v[64:79], v[32:35], v[212:215], v[64:79]
    ds_read_b64_tr_b16 v[48:49], v16 offset:12288
    ds_read_b64_tr_b16 v[50:51], v16 offset:12800
    ds_read_b64_tr_b16 v[52:53], v17 offset:12288
    v_mfma_f32_16x16x32_bf16 v[80:83], v[36:39], v[56:59], v[80:83]
    ds_read_b64_tr_b16 v[54:55], v17 offset:12800
    buffer_load_dwordx4 v31, s[32:35], s3 offen offset:1024 lds
    v_dot2c_f32_bf16 v112, v208, v116
    v_dot2c_f32_bf16 v114, v208, v208
    v_dot2c_f32_bf16 v113, v209, v116
    v_dot2c_f32_bf16 v115, v209, v209
    v_dot2c_f32_bf16 v112, v210, v116
    v_dot2c_f32_bf16 v114, v210, v210
    v_dot2c_f32_bf16 v113, v211, v116
    v_dot2c_f32_bf16 v115, v211, v211
    v_dot2c_f32_bf16 v112, v212, v116
    v_dot2c_f32_bf16 v114, v212, v212
    v_dot2c_f32_bf16 v113, v213, v116
    v_dot2c_f32_bf16 v115, v213, v213
    v_dot2c_f32_bf16 v112, v214, v116
    v_dot2c_f32_bf16 v114, v214, v214
    v_dot2c_f32_bf16 v113, v215, v116
    v_dot2c_f32_bf16 v115, v215, v215
    v_dot2c_f32_bf16 v112, v216, v116
    v_dot2c_f32_bf16 v114, v216, v216
    v_dot2c_f32_bf16 v113, v217, v116
    v_dot2c_f32_bf16 v115, v217, v217
    v_dot2c_f32_bf16 v112, v218, v116
    v_dot2c_f32_bf16 v114, v218, v218
    v_dot2c_f32_bf16 v113, v219, v116
    v_dot2c_f32_bf16 v115, v219, v219
    v_dot2c_f32_bf16 v112, v220, v116
    v_dot2c_f32_bf16 v114, v220, v220
    v_dot2c_f32_bf16 v113, v221, v116
    v_dot2c_f32_bf16 v115, v221, v221
    v_dot2c_f32_bf16 v112, v222, v116
    v_dot2c_f32_bf16 v114, v222, v222
    v_dot2c_f32_bf16 v113, v223, v116
    v_dot2c_f32_bf16 v115, v223, v223
    s_waitcnt vmcnt(4) lgkmcnt(0)
    s_barrier
    v_subrev_u32 v12, 65536, v12
    v_subrev_u32 v13, 65536, v13
    v_subrev_u32 v14, 65536, v14
    v_subrev_u32 v15, 65536, v15
    v_subrev_u32 v16, 65536, v16
    v_subrev_u32 v17, 65536, v17
    v_mfma_f32_32x32x16_bf16 v[64:79], v[40:43], v[216:219], v[64:79]
    ds_read_b128 v[224:227], v12 offset:0
    ds_read_b128 v[228:231], v13 offset:0
    ds_read_b64_tr_b16 v[32:33], v16 offset:0
    ds_read_b64_tr_b16 v[34:35], v16 offset:512
    ds_read_b64_tr_b16 v[36:37], v17 offset:0
    v_mfma_f32_16x16x32_bf16 v[80:83], v[44:47], v[56:59], v[80:83]
    ds_read_b64_tr_b16 v[38:39], v17 offset:512
    s_add_u32 m0, s49, 57344
    s_mul_i32 s3, s53, 229376
    s_add_u32 s3, s3, 128
    buffer_load_dwordx4 v30, s[32:35], s3 offen lds
    v_mfma_f32_32x32x16_bf16 v[64:79], v[48:51], v[220:223], v[64:79]
    ds_read_b128 v[232:235], v14 offset:0
    ds_read_b128 v[236:239], v15 offset:0
    ds_read_b64_tr_b16 v[40:41], v16 offset:4096
    v_mfma_f32_16x16x32_bf16 v[80:83], v[52:55], v[56:59], v[80:83]
    ds_read_b64_tr_b16 v[42:43], v16 offset:4608
    ds_read_b64_tr_b16 v[44:45], v17 offset:4096
    ds_read_b64_tr_b16 v[46:47], v17 offset:4608
    s_waitcnt lgkmcnt(6)
    v_mfma_f32_32x32x16_bf16 v[64:79], v[32:35], v[224:227], v[64:79]
    ds_read_b64_tr_b16 v[48:49], v16 offset:8192
    ds_read_b64_tr_b16 v[50:51], v16 offset:8704
    ds_read_b64_tr_b16 v[52:53], v17 offset:8192
    v_mfma_f32_16x16x32_bf16 v[80:83], v[36:39], v[56:59], v[80:83]
    ds_read_b64_tr_b16 v[54:55], v17 offset:8704
    buffer_load_dwordx4 v31, s[32:35], s3 offen offset:1024 lds
    buffer_load_dwordx2 v[62:63], v8, s[60:63], 0 offen sc1
    s_lshl_b32 s44, s38, 10
    s_add_u32 s44, s44, 17301504
    v_and_b32 v25, 1, v1
    v_lshlrev_b32 v25, 9, v25
    buffer_load_dwordx2 v[28:29], v25, s[20:23], s44 offen offset:256 sc1
    s_waitcnt lgkmcnt(4)
    v_mfma_f32_32x32x16_bf16 v[64:79], v[40:43], v[228:231], v[64:79]
    ds_read_b64_tr_b16 v[32:33], v16 offset:12288
    ds_read_b64_tr_b16 v[34:35], v16 offset:12800
    v_mfma_f32_16x16x32_bf16 v[80:83], v[44:47], v[56:59], v[80:83]
    ds_read_b64_tr_b16 v[36:37], v17 offset:12288
    ds_read_b64_tr_b16 v[38:39], v17 offset:12800
    v_dot2c_f32_bf16 v112, v224, v116
    v_dot2c_f32_bf16 v114, v224, v224
    v_dot2c_f32_bf16 v113, v225, v116
    v_dot2c_f32_bf16 v115, v225, v225
    v_dot2c_f32_bf16 v112, v226, v116
    v_dot2c_f32_bf16 v114, v226, v226
    v_dot2c_f32_bf16 v113, v227, v116
    v_dot2c_f32_bf16 v115, v227, v227
    v_dot2c_f32_bf16 v112, v228, v116
    v_dot2c_f32_bf16 v114, v228, v228
    v_dot2c_f32_bf16 v113, v229, v116
    v_dot2c_f32_bf16 v115, v229, v229
    v_dot2c_f32_bf16 v112, v230, v116
    v_dot2c_f32_bf16 v114, v230, v230
    v_dot2c_f32_bf16 v113, v231, v116
    v_dot2c_f32_bf16 v115, v231, v231
    v_dot2c_f32_bf16 v112, v232, v116
    v_dot2c_f32_bf16 v114, v232, v232
    v_dot2c_f32_bf16 v113, v233, v116
    v_dot2c_f32_bf16 v115, v233, v233
    v_dot2c_f32_bf16 v112, v234, v116
    v_dot2c_f32_bf16 v114, v234, v234
    v_dot2c_f32_bf16 v113, v235, v116
    v_dot2c_f32_bf16 v115, v235, v235
    v_dot2c_f32_bf16 v112, v236, v116
    v_dot2c_f32_bf16 v114, v236, v236
    v_dot2c_f32_bf16 v113, v237, v116
    v_dot2c_f32_bf16 v115, v237, v237
    v_dot2c_f32_bf16 v112, v238, v116
    v_dot2c_f32_bf16 v114, v238, v238
    v_dot2c_f32_bf16 v113, v239, v116
    v_dot2c_f32_bf16 v115, v239, v239
    s_waitcnt lgkmcnt(4)
    v_mfma_f32_32x32x16_bf16 v[64:79], v[48:51], v[232:235], v[64:79]
    v_mfma_f32_16x16x32_bf16 v[80:83], v[52:55], v[56:59], v[80:83]
    v_add_f32 v112, v112, v113
    v_add_f32 v114, v114, v115
    v_mov_b32 v113, v112
    v_mov_b32 v115, v114
    v_and_b32 v21, 31, v1
    s_lshl_b32 s44, s36, 8
    s_add_u32 s44, s44, 155648
    v_lshl_add_u32 v21, v21, 3, s44
    v_permlane32_swap_b32 v112, v113
    v_permlane32_swap_b32 v114, v115
    v_add_f32 v18, v112, v113
    v_add_f32 v19, v114, v115
    ds_write_b64 v21, v[18:19] offset:1024
    s_waitcnt lgkmcnt(1)
    v_mfma_f32_32x32x16_bf16 v[64:79], v[32:35], v[236:239], v[64:79]
    v_mfma_f32_16x16x32_bf16 v[80:83], v[36:39], v[56:59], v[80:83]
    s_min_u32 s3, s36, 2
    s_lshl_b32 s3, s3, 7
    s_add_u32 s3, s3, 161792
    v_and_b32 v10, 1, v1
    v_lshlrev_b32 v10, 6, v10
    v_and_b32 v11, 48, v1
    v_add3_u32 v10, v10, v11, s3
    s_mov_b32 exec_lo, 0x00030003
    s_mov_b32 exec_hi, 0x00030003
    ds_write_b128 v10, v[80:83]
    s_mov_b64 exec, -1
    s_waitcnt vmcnt(6)
    s_waitcnt lgkmcnt(0)
    s_barrier
    ds_read_b128 v[96:99], v9 offset:256
    ds_read_b128 v[100:103], v9 offset:288
    ds_read_b128 v[104:107], v9 offset:320
    ds_read_b128 v[108:111], v9 offset:352
    v_mul_f32 v18, 0xbb124925, v18
    v_mul_f32 v19, 0x3b124925, v19
    v_fma_f32 v19, -v18, v18, v19
    v_max_f32 v19, 0, v19
    v_add_f32 v19, 0x3727c5ac, v19
    v_rsq_f32 v20, v19
    v_sqrt_f32 v23, v19
    v_mov_b32 v19, v18
    v_mul_f32 v22, 0xbfb8aa3b, v20
    s_mul_i32 s3, s38, 3
    s_cmp_lt_u32 s3, 12
    s_cselect_b32 s3, 0x3e8b97f6, 1.0
    v_mul_f32 v26, s3, v20
    s_waitcnt lgkmcnt(0)
    v_mov_b32 v27, v26
    v_pk_fma_f32 v[64:65], v[96:97], v[18:19], v[64:65]
    v_pk_fma_f32 v[66:67], v[98:99], v[18:19], v[66:67]
    v_pk_fma_f32 v[68:69], v[100:101], v[18:19], v[68:69]
    v_pk_fma_f32 v[70:71], v[102:103], v[18:19], v[70:71]
    v_pk_fma_f32 v[72:73], v[104:105], v[18:19], v[72:73]
    v_pk_fma_f32 v[74:75], v[106:107], v[18:19], v[74:75]
    v_pk_fma_f32 v[76:77], v[108:109], v[18:19], v[76:77]
    v_pk_fma_f32 v[78:79], v[110:111], v[18:19], v[78:79]
    v_pk_mul_f32 v[64:65], v[64:65], v[26:27]
    v_pk_mul_f32 v[66:67], v[66:67], v[26:27]
    v_pk_mul_f32 v[68:69], v[68:69], v[26:27]
    v_pk_mul_f32 v[70:71], v[70:71], v[26:27]
    v_pk_mul_f32 v[72:73], v[72:73], v[26:27]
    v_pk_mul_f32 v[74:75], v[74:75], v[26:27]
    v_pk_mul_f32 v[76:77], v[76:77], v[26:27]
    v_pk_mul_f32 v[78:79], v[78:79], v[26:27]
    v_cvt_pk_bf16_f32 v64, v64, v65
    v_cvt_pk_bf16_f32 v65, v66, v67
    v_cvt_pk_bf16_f32 v66, v68, v69
    v_cvt_pk_bf16_f32 v67, v70, v71
    buffer_store_dwordx4 v[64:67], v2, s[20:23], s57 offen offset:0 sc1
    v_cvt_pk_bf16_f32 v68, v72, v73
    v_cvt_pk_bf16_f32 v69, v74, v75
    v_cvt_pk_bf16_f32 v70, v76, v77
    v_cvt_pk_bf16_f32 v71, v78, v79
    buffer_store_dwordx4 v[68:71], v2, s[20:23], s57 offen offset:1024 sc1
    s_mov_b32 s47, 0
    s_waitcnt vmcnt(3)
    s_branch L_nz_23c
L_nz_23:
    buffer_load_dwordx2 v[62:63], v8, s[60:63], 0 offen sc1
    s_waitcnt vmcnt(0)
L_nz_23c:
    v_readfirstlane_b32 s81, v63
    v_readfirstlane_b32 s80, v62
    s_add_u32 s47, s47, 1
    s_cmp_lg_u32 s81, 0
    s_cbranch_scc1 L_nze_24
    s_sleep 2
    s_cmp_lt_u32 s47, 200000
    s_cbranch_scc1 L_nz_23
L_nze_24:
    s_waitcnt vmcnt(2)
    v_cmp_ne_u64 vcc, s[80:81], v[28:29]
    s_nop 0
    s_mov_b32 s19, vcc_lo
    s_cbranch_vccnz L_cst_25
    s_lshl_b32 s3, s38, 10
    s_add_u32 s3, s3, 17301504
    s_mov_b32 m0, 162176
    v_lshrrev_b32 v10, 5, v1
    v_lshlrev_b32 v10, 7, v10
    v_and_b32 v11, 31, v1
    v_add_lshl_u32 v10, v10, v11, 2
    buffer_load_dword v10, s[20:23], s3 offen sc1 lds
L_cst_25:
    s_setprio 2
    v_add_u32 v16, 98304, v24
    v_add_u32 v17, 32768, v24
    ds_read_b64_tr_b16 v[32:33], v16 offset:0
    ds_read_b64_tr_b16 v[34:35], v16 offset:512
    ds_read_b64_tr_b16 v[36:37], v16 offset:2048
    ds_read_b64_tr_b16 v[38:39], v16 offset:2560
    ds_read_b64_tr_b16 v[40:41], v16 offset:4096
    ds_read_b64_tr_b16 v[42:43], v16 offset:4608
    ds_read_b64_tr_b16 v[44:45], v16 offset:6144
    ds_read_b64_tr_b16 v[46:47], v16 offset:6656
    ds_read_b64_tr_b16 v[48:49], v16 offset:8192
    ds_read_b64_tr_b16 v[50:51], v16 offset:8704
    s_waitcnt lgkmcnt(6)
    v_mfma_f32_32x32x16_bf16 v[80:95], v[32:35], v[128:131], 0
    ds_read_b64_tr_b16 v[52:53], v16 offset:10240
    ds_read_b64_tr_b16 v[54:55], v16 offset:10752
    v_mfma_f32_32x32x16_bf16 v[80:95], v[36:39], v[132:135], v[80:95]
    ds_read_b64_tr_b16 v[32:33], v16 offset:12288
    ds_read_b64_tr_b16 v[34:35], v16 offset:12800
    s_waitcnt lgkmcnt(6)
    v_mfma_f32_32x32x16_bf16 v[80:95], v[40:43], v[136:139], v[80:95]
    ds_read_b64_tr_b16 v[36:37], v16 offset:14336
    ds_read_b64_tr_b16 v[38:39], v16 offset:14848
    v_mfma_f32_32x32x16_bf16 v[80:95], v[44:47], v[140:143], v[80:95]
    ds_read_b64_tr_b16 v[40:41], v16 offset:16384
    ds_read_b64_tr_b16 v[42:43], v16 offset:16896
    s_waitcnt lgkmcnt(6)
    v_mfma_f32_32x32x16_bf16 v[80:95], v[48:51], v[144:147], v[80:95]
    ds_read_b64_tr_b16 v[44:45], v16 offset:18432
    ds_read_b64_tr_b16 v[46:47], v16 offset:18944
    v_mfma_f32_32x32x16_bf16 v[80:95], v[52:55], v[148:151], v[80:95]
    ds_read_b64_tr_b16 v[48:49], v16 offset:20480
    ds_read_b64_tr_b16 v[50:51], v16 offset:20992
    s_waitcnt lgkmcnt(6)
    v_mfma_f32_32x32x16_bf16 v[80:95], v[32:35], v[152:155], v[80:95]
    ds_read_b64_tr_b16 v[52:53], v16 offset:22528
    ds_read_b64_tr_b16 v[54:55], v16 offset:23040
    v_mfma_f32_32x32x16_bf16 v[80:95], v[36:39], v[156:159], v[80:95]
    ds_read_b64_tr_b16 v[32:33], v16 offset:24576
    ds_read_b64_tr_b16 v[34:35], v16 offset:25088
    s_waitcnt lgkmcnt(6)
    v_mfma_f32_32x32x16_bf16 v[80:95], v[40:43], v[160:163], v[80:95]
    ds_read_b64_tr_b16 v[36:37], v16 offset:26624
    ds_read_b64_tr_b16 v[38:39], v16 offset:27136
    v_mfma_f32_32x32x16_bf16 v[80:95], v[44:47], v[164:167], v[80:95]
    ds_read_b64_tr_b16 v[40:41], v16 offset:28672
    ds_read_b64_tr_b16 v[42:43], v16 offset:29184
    s_waitcnt lgkmcnt(6)
    v_mfma_f32_32x32x16_bf16 v[80:95], v[48:51], v[168:171], v[80:95]
    ds_read_b64_tr_b16 v[44:45], v16 offset:30720
    ds_read_b64_tr_b16 v[46:47], v16 offset:31232
    v_mfma_f32_32x32x16_bf16 v[80:95], v[52:55], v[172:175], v[80:95]
    ds_read_b64_tr_b16 v[48:49], v16 offset:32768
    ds_read_b64_tr_b16 v[50:51], v16 offset:33280
    s_waitcnt lgkmcnt(6)
    v_mfma_f32_32x32x16_bf16 v[80:95], v[32:35], v[176:179], v[80:95]
    ds_read_b64_tr_b16 v[52:53], v16 offset:34816
    ds_read_b64_tr_b16 v[54:55], v16 offset:35328
    v_mfma_f32_32x32x16_bf16 v[80:95], v[36:39], v[180:183], v[80:95]
    ds_read_b64_tr_b16 v[32:33], v16 offset:36864
    ds_read_b64_tr_b16 v[34:35], v16 offset:37376
    s_waitcnt lgkmcnt(6)
    v_mfma_f32_32x32x16_bf16 v[80:95], v[40:43], v[184:187], v[80:95]
    ds_read_b64_tr_b16 v[36:37], v16 offset:38912
    ds_read_b64_tr_b16 v[38:39], v16 offset:39424
    v_mfma_f32_32x32x16_bf16 v[80:95], v[44:47], v[188:191], v[80:95]
    ds_read_b64_tr_b16 v[40:41], v16 offset:40960
    ds_read_b64_tr_b16 v[42:43], v16 offset:41472
    s_waitcnt lgkmcnt(6)
    v_mfma_f32_32x32x16_bf16 v[80:95], v[48:51], v[192:195], v[80:95]
    ds_read_b64_tr_b16 v[44:45], v16 offset:43008
    ds_read_b64_tr_b16 v[46:47], v16 offset:43520
    v_mfma_f32_32x32x16_bf16 v[80:95], v[52:55], v[196:199], v[80:95]
    ds_read_b64_tr_b16 v[48:49], v16 offset:45056
    ds_read_b64_tr_b16 v[50:51], v16 offset:45568
    s_waitcnt lgkmcnt(6)
    v_mfma_f32_32x32x16_bf16 v[80:95], v[32:35], v[200:203], v[80:95]
    ds_read_b64_tr_b16 v[52:53], v16 offset:47104
    ds_read_b64_tr_b16 v[54:55], v16 offset:47616
    v_mfma_f32_32x32x16_bf16 v[80:95], v[36:39], v[204:207], v[80:95]
    ds_read_b64_tr_b16 v[32:33], v16 offset:49152
    ds_read_b64_tr_b16 v[34:35], v16 offset:49664
    s_waitcnt lgkmcnt(6)
    v_mfma_f32_32x32x16_bf16 v[80:95], v[40:43], v[208:211], v[80:95]
    ds_read_b64_tr_b16 v[36:37], v16 offset:51200
    ds_read_b64_tr_b16 v[38:39], v16 offset:51712
    v_mfma_f32_32x32x16_bf16 v[80:95], v[44:47], v[212:215], v[80:95]
    ds_read_b64_tr_b16 v[40:41], v16 offset:53248
    ds_read_b64_tr_b16 v[42:43], v16 offset:53760
    s_waitcnt lgkmcnt(6)
    v_mfma_f32_32x32x16_bf16 v[80:95], v[48:51], v[216:219], v[80:95]
    ds_read_b64_tr_b16 v[44:45], v16 offset:55296
    ds_read_b64_tr_b16 v[46:47], v16 offset:55808
    v_mfma_f32_32x32x16_bf16 v[80:95], v[52:55], v[220:223], v[80:95]
    s_waitcnt lgkmcnt(4)
    v_mfma_f32_32x32x16_bf16 v[80:95], v[32:35], v[224:227], v[80:95]
    v_mfma_f32_32x32x16_bf16 v[80:95], v[36:39], v[228:231], v[80:95]
    s_waitcnt lgkmcnt(0)
    v_mfma_f32_32x32x16_bf16 v[80:95], v[40:43], v[232:235], v[80:95]
    v_mfma_f32_32x32x16_bf16 v[80:95], v[44:47], v[236:239], v[80:95]
    s_mov_b64 exec, 1
    v_mov_b32 v11, 1
    ds_add_u32 v7, v11 offset:8
    s_mov_b64 exec, -1
    s_mov_b64 exec, 1
    v_mov_b32 v11, 1
    ds_add_u32 v7, v11 offset:4
    s_mov_b64 exec, -1
    s_waitcnt vmcnt(0)
    v_lshlrev_b32 v11, 3, v1
    s_mov_b64 exec, 65535
    buffer_store_dwordx2 v[62:63], v11, s[20:23], s59 offen offset:0 sc1
    s_mov_b64 exec, -1
    s_cmp_eq_u32 s19, 0
    s_cbranch_scc1 L_csl_26
    s_lshl_b32 s44, s38, 10
    s_add_u32 s44, s44, 17301504
    s_mov_b64 exec, 3
    s_mov_b32 s47, 0
L_poll_27:
    buffer_load_dwordx2 v[28:29], v25, s[20:23], s44 offen offset:256 sc1
    s_add_u32 s47, s47, 1
    s_waitcnt vmcnt(0)
    v_cmp_ne_u64 vcc, s[80:81], v[28:29]
    s_nop 0
    s_cbranch_vccz L_polle_28
    s_sleep 4
    s_cmp_lt_u32 s47, 200000
    s_cbranch_scc1 L_poll_27
L_polle_28:
    s_mov_b64 exec, -1
    s_lshl_b32 s3, s38, 10
    s_add_u32 s3, s3, 17301504
    s_mov_b32 m0, 162176
    v_lshrrev_b32 v10, 5, v1
    v_lshlrev_b32 v10, 7, v10
    v_and_b32 v11, 31, v1
    v_add_lshl_u32 v10, v10, v11, 2
    buffer_load_dword v10, s[20:23], s3 offen sc1 lds
    s_waitcnt vmcnt(0)
L_csl_26:
    ds_read_b128 v[240:243], v9 offset:384
    ds_read_b128 v[244:247], v9 offset:416
    ds_read_b128 v[248:251], v9 offset:448
    ds_read_b128 v[252:255], v9 offset:480
    ds_read_b128 v[96:99], v9 offset:512
    ds_read_b128 v[100:103], v9 offset:544
    ds_read_b128 v[104:107], v9 offset:576
    ds_read_b128 v[108:111], v9 offset:608
    s_waitcnt lgkmcnt(4)
    v_fma_f32 v80, v240, v18, v80
    v_fma_f32 v81, v241, v18, v81
    v_fma_f32 v82, v242, v18, v82
    v_fma_f32 v83, v243, v18, v83
    v_mul_f32 v112, v22, v80
    v_mul_f32 v113, v22, v81
    v_mul_f32 v114, v22, v82
    v_mul_f32 v115, v22, v83
    v_exp_f32 v112, v112
    v_exp_f32 v113, v113
    v_exp_f32 v114, v114
    v_exp_f32 v115, v115
    v_fma_f32 v112, v112, v23, v23
    v_fma_f32 v113, v113, v23, v23
    v_fma_f32 v114, v114, v23, v23
    v_fma_f32 v115, v115, v23, v23
    v_rcp_f32 v112, v112
    v_rcp_f32 v113, v113
    v_rcp_f32 v114, v114
    v_rcp_f32 v115, v115
    v_mul_f32 v80, v112, v80
    v_mul_f32 v81, v113, v81
    v_mul_f32 v82, v114, v82
    v_mul_f32 v83, v115, v83
    v_fma_f32 v84, v244, v18, v84
    v_fma_f32 v85, v245, v18, v85
    v_fma_f32 v86, v246, v18, v86
    v_fma_f32 v87, v247, v18, v87
    v_mul_f32 v116, v22, v84
    v_mul_f32 v117, v22, v85
    v_mul_f32 v118, v22, v86
    v_mul_f32 v119, v22, v87
    v_exp_f32 v116, v116
    v_exp_f32 v117, v117
    v_exp_f32 v118, v118
    v_exp_f32 v119, v119
    v_fma_f32 v116, v116, v23, v23
    v_fma_f32 v117, v117, v23, v23
    v_fma_f32 v118, v118, v23, v23
    v_fma_f32 v119, v119, v23, v23
    v_rcp_f32 v116, v116
    v_rcp_f32 v117, v117
    v_rcp_f32 v118, v118
    v_rcp_f32 v119, v119
    v_mul_f32 v84, v116, v84
    v_mul_f32 v85, v117, v85
    v_mul_f32 v86, v118, v86
    v_mul_f32 v87, v119, v87
    v_cvt_pk_bf16_f32 v80, v80, v81
    v_cvt_pk_bf16_f32 v81, v82, v83
    v_cvt_pk_bf16_f32 v82, v84, v85
    v_cvt_pk_bf16_f32 v83, v86, v87
    buffer_store_dwordx4 v[80:83], v2, s[20:23], s58 offen offset:0 sc1
    v_fma_f32 v88, v248, v18, v88
    v_fma_f32 v89, v249, v18, v89
    v_fma_f32 v90, v250, v18, v90
    v_fma_f32 v91, v251, v18, v91
    v_mul_f32 v120, v22, v88
    v_mul_f32 v121, v22, v89
    v_mul_f32 v122, v22, v90
    v_mul_f32 v123, v22, v91
    v_exp_f32 v120, v120
    v_exp_f32 v121, v121
    v_exp_f32 v122, v122
    v_exp_f32 v123, v123
    v_fma_f32 v120, v120, v23, v23
    v_fma_f32 v121, v121, v23, v23
    v_fma_f32 v122, v122, v23, v23
    v_fma_f32 v123, v123, v23, v23
    v_rcp_f32 v120, v120
    v_rcp_f32 v121, v121
    v_rcp_f32 v122, v122
    v_rcp_f32 v123, v123
    v_mul_f32 v88, v120, v88
    v_mul_f32 v89, v121, v89
    v_mul_f32 v90, v122, v90
    v_mul_f32 v91, v123, v91
    v_fma_f32 v92, v252, v18, v92
    v_fma_f32 v93, v253, v18, v93
    v_fma_f32 v94, v254, v18, v94
    v_fma_f32 v95, v255, v18, v95
    v_mul_f32 v124, v22, v92
    v_mul_f32 v125, v22, v93
    v_mul_f32 v126, v22, v94
    v_mul_f32 v127, v22, v95
    v_exp_f32 v124, v124
    v_exp_f32 v125, v125
    v_exp_f32 v126, v126
    v_exp_f32 v127, v127
    v_fma_f32 v124, v124, v23, v23
    v_fma_f32 v125, v125, v23, v23
    v_fma_f32 v126, v126, v23, v23
    v_fma_f32 v127, v127, v23, v23
    v_rcp_f32 v124, v124
    v_rcp_f32 v125, v125
    v_rcp_f32 v126, v126
    v_rcp_f32 v127, v127
    v_mul_f32 v92, v124, v92
    v_mul_f32 v93, v125, v93
    v_mul_f32 v94, v126, v94
    v_mul_f32 v95, v127, v95
    v_cvt_pk_bf16_f32 v84, v88, v89
    v_cvt_pk_bf16_f32 v85, v90, v91
    v_cvt_pk_bf16_f32 v86, v92, v93
    v_cvt_pk_bf16_f32 v87, v94, v95
    buffer_store_dwordx4 v[84:87], v2, s[20:23], s58 offen offset:1024 sc1
    s_add_u32 s58, s58, 4096
    s_mov_b32 s47, 0
L_sp_29:
    ds_read_b32 v11, v7 offset:4
    s_add_u32 s47, s47, 1
    s_waitcnt lgkmcnt(0)
    v_cmp_gt_u32 vcc, 8, v11
    s_nop 0
    s_cbranch_vccz L_spe_30
    s_cmp_lt_u32 s47, 1600000
    s_cbranch_scc1 L_sp_29
L_spe_30:
    ds_read_b64_tr_b16 v[32:33], v17 offset:0
    ds_read_b64_tr_b16 v[34:35], v17 offset:512
    ds_read_b64_tr_b16 v[36:37], v17 offset:2048
    ds_read_b64_tr_b16 v[38:39], v17 offset:2560
    ds_read_b64_tr_b16 v[40:41], v17 offset:4096
    ds_read_b64_tr_b16 v[42:43], v17 offset:4608
    ds_read_b64_tr_b16 v[44:45], v17 offset:6144
    ds_read_b64_tr_b16 v[46:47], v17 offset:6656
    ds_read_b64_tr_b16 v[48:49], v17 offset:8192
    ds_read_b64_tr_b16 v[50:51], v17 offset:8704
    s_waitcnt lgkmcnt(6)
    v_mfma_f32_32x32x16_bf16 v[64:79], v[32:35], v[128:131], 0
    ds_read_b64_tr_b16 v[52:53], v17 offset:10240
    ds_read_b64_tr_b16 v[54:55], v17 offset:10752
    v_mfma_f32_32x32x16_bf16 v[64:79], v[36:39], v[132:135], v[64:79]
    ds_read_b64_tr_b16 v[32:33], v17 offset:12288
    ds_read_b64_tr_b16 v[34:35], v17 offset:12800
    s_waitcnt lgkmcnt(6)
    v_mfma_f32_32x32x16_bf16 v[64:79], v[40:43], v[136:139], v[64:79]
    ds_read_b64_tr_b16 v[36:37], v17 offset:14336
    ds_read_b64_tr_b16 v[38:39], v17 offset:14848
    v_mfma_f32_32x32x16_bf16 v[64:79], v[44:47], v[140:143], v[64:79]
    ds_read_b64_tr_b16 v[40:41], v17 offset:16384
    ds_read_b64_tr_b16 v[42:43], v17 offset:16896
    s_waitcnt lgkmcnt(6)
    v_mfma_f32_32x32x16_bf16 v[64:79], v[48:51], v[144:147], v[64:79]
    ds_read_b64_tr_b16 v[44:45], v17 offset:18432
    ds_read_b64_tr_b16 v[46:47], v17 offset:18944
    v_mfma_f32_32x32x16_bf16 v[64:79], v[52:55], v[148:151], v[64:79]
    ds_read_b64_tr_b16 v[48:49], v17 offset:20480
    ds_read_b64_tr_b16 v[50:51], v17 offset:20992
    s_waitcnt lgkmcnt(6)
    v_mfma_f32_32x32x16_bf16 v[64:79], v[32:35], v[152:155], v[64:79]
    ds_read_b64_tr_b16 v[52:53], v17 offset:22528
    ds_read_b64_tr_b16 v[54:55], v17 offset:23040
    v_mfma_f32_32x32x16_bf16 v[64:79], v[36:39], v[156:159], v[64:79]
    ds_read_b64_tr_b16 v[32:33], v17 offset:24576
    ds_read_b64_tr_b16 v[34:35], v17 offset:25088
    s_waitcnt lgkmcnt(6)
    v_mfma_f32_32x32x16_bf16 v[64:79], v[40:43], v[160:163], v[64:79]
    ds_read_b64_tr_b16 v[36:37], v17 offset:26624
    ds_read_b64_tr_b16 v[38:39], v17 offset:27136
    v_mfma_f32_32x32x16_bf16 v[64:79], v[44:47], v[164:167], v[64:79]
    ds_read_b64_tr_b16 v[40:41], v17 offset:28672
    ds_read_b64_tr_b16 v[42:43], v17 offset:29184
    s_waitcnt lgkmcnt(6)
    v_mfma_f32_32x32x16_bf16 v[64:79], v[48:51], v[168:171], v[64:79]
    ds_read_b64_tr_b16 v[44:45], v17 offset:30720
    ds_read_b64_tr_b16 v[46:47], v17 offset:31232
    v_mfma_f32_32x32x16_bf16 v[64:79], v[52:55], v[172:175], v[64:79]
    ds_read_b64_tr_b16 v[48:49], v17 offset:32768
    ds_read_b64_tr_b16 v[50:51], v17 offset:33280
    s_waitcnt lgkmcnt(6)
    v_mfma_f32_32x32x16_bf16 v[64:79], v[32:35], v[176:179], v[64:79]
    ds_read_b64_tr_b16 v[52:53], v17 offset:34816
    ds_read_b64_tr_b16 v[54:55], v17 offset:35328
    v_mfma_f32_32x32x16_bf16 v[64:79], v[36:39], v[180:183], v[64:79]
    ds_read_b64_tr_b16 v[32:33], v17 offset:36864
    ds_read_b64_tr_b16 v[34:35], v17 offset:37376
    s_waitcnt lgkmcnt(6)
    v_mfma_f32_32x32x16_bf16 v[64:79], v[40:43], v[184:187], v[64:79]
    ds_read_b64_tr_b16 v[36:37], v17 offset:38912
    ds_read_b64_tr_b16 v[38:39], v17 offset:39424
    v_mfma_f32_32x32x16_bf16 v[64:79], v[44:47], v[188:191], v[64:79]
    ds_read_b64_tr_b16 v[40:41], v17 offset:40960
    ds_read_b64_tr_b16 v[42:43], v17 offset:41472
    s_waitcnt lgkmcnt(6)
    v_mfma_f32_32x32x16_bf16 v[64:79], v[48:51], v[192:195], v[64:79]
    ds_read_b64_tr_b16 v[44:45], v17 offset:43008
    ds_read_b64_tr_b16 v[46:47], v17 offset:43520
    v_mfma_f32_32x32x16_bf16 v[64:79], v[52:55], v[196:199], v[64:79]
    ds_read_b64_tr_b16 v[48:49], v17 offset:45056
    ds_read_b64_tr_b16 v[50:51], v17 offset:45568
    s_waitcnt lgkmcnt(6)
    v_mfma_f32_32x32x16_bf16 v[64:79], v[32:35], v[200:203], v[64:79]
    ds_read_b64_tr_b16 v[52:53], v17 offset:47104
    ds_read_b64_tr_b16 v[54:55], v17 offset:47616
    v_mfma_f32_32x32x16_bf16 v[64:79], v[36:39], v[204:207], v[64:79]
    ds_read_b64_tr_b16 v[32:33], v17 offset:49152
    ds_read_b64_tr_b16 v[34:35], v17 offset:49664
    s_waitcnt lgkmcnt(6)
    v_mfma_f32_32x32x16_bf16 v[64:79], v[40:43], v[208:211], v[64:79]
    ds_read_b64_tr_b16 v[36:37], v17 offset:51200
    ds_read_b64_tr_b16 v[38:39], v17 offset:51712
    v_mfma_f32_32x32x16_bf16 v[64:79], v[44:47], v[212:215], v[64:79]
    ds_read_b64_tr_b16 v[40:41], v17 offset:53248
    ds_read_b64_tr_b16 v[42:43], v17 offset:53760
    s_waitcnt lgkmcnt(6)
    v_mfma_f32_32x32x16_bf16 v[64:79], v[48:51], v[216:219], v[64:79]
    ds_read_b64_tr_b16 v[44:45], v17 offset:55296
    ds_read_b64_tr_b16 v[46:47], v17 offset:55808
    v_mfma_f32_32x32x16_bf16 v[64:79], v[52:55], v[220:223], v[64:79]
    s_waitcnt lgkmcnt(4)
    v_mfma_f32_32x32x16_bf16 v[64:79], v[32:35], v[224:227], v[64:79]
    v_mfma_f32_32x32x16_bf16 v[64:79], v[36:39], v[228:231], v[64:79]
    s_waitcnt lgkmcnt(0)
    v_mfma_f32_32x32x16_bf16 v[64:79], v[40:43], v[232:235], v[64:79]
    v_mfma_f32_32x32x16_bf16 v[64:79], v[44:47], v[236:239], v[64:79]
    buffer_load_dwordx2 v[28:29], v5, s[20:23], 0 offen sc1
    s_mov_b64 exec, 1
    v_mov_b32 v11, 1
    ds_add_u32 v7, v11 offset:12
    s_mov_b64 exec, -1
    s_mov_b32 s47, 0
L_sp_31:
    ds_read_b32 v11, v7 offset:8
    s_add_u32 s47, s47, 1
    s_waitcnt lgkmcnt(0)
    v_cmp_gt_u32 vcc, 8, v11
    s_nop 0
    s_cbranch_vccz L_spe_32
    s_cmp_lt_u32 s47, 1600000
    s_cbranch_scc1 L_sp_31
L_spe_32:
    v_fma_f32 v64, v96, v18, v64
    v_fma_f32 v65, v97, v18, v65
    v_fma_f32 v66, v98, v18, v66
    v_fma_f32 v67, v99, v18, v67
    v_mul_f32 v112, v22, v64
    v_mul_f32 v113, v22, v65
    v_mul_f32 v114, v22, v66
    v_mul_f32 v115, v22, v67
    v_exp_f32 v112, v112
    v_exp_f32 v113, v113
    v_exp_f32 v114, v114
    v_exp_f32 v115, v115
    v_fma_f32 v112, v112, v23, v23
    v_fma_f32 v113, v113, v23, v23
    v_fma_f32 v114, v114, v23, v23
    v_fma_f32 v115, v115, v23, v23
    v_rcp_f32 v112, v112
    v_rcp_f32 v113, v113
    v_rcp_f32 v114, v114
    v_rcp_f32 v115, v115
    v_mul_f32 v64, v112, v64
    v_mul_f32 v65, v113, v65
    v_mul_f32 v66, v114, v66
    v_mul_f32 v67, v115, v67
    v_fma_f32 v68, v100, v18, v68
    v_fma_f32 v69, v101, v18, v69
    v_fma_f32 v70, v102, v18, v70
    v_fma_f32 v71, v103, v18, v71
    v_mul_f32 v116, v22, v68
    v_mul_f32 v117, v22, v69
    v_mul_f32 v118, v22, v70
    v_mul_f32 v119, v22, v71
    v_exp_f32 v116, v116
    v_exp_f32 v117, v117
    v_exp_f32 v118, v118
    v_exp_f32 v119, v119
    v_fma_f32 v116, v116, v23, v23
    v_fma_f32 v117, v117, v23, v23
    v_fma_f32 v118, v118, v23, v23
    v_fma_f32 v119, v119, v23, v23
    v_rcp_f32 v116, v116
    v_rcp_f32 v117, v117
    v_rcp_f32 v118, v118
    v_rcp_f32 v119, v119
    v_mul_f32 v68, v116, v68
    v_mul_f32 v69, v117, v69
    v_mul_f32 v70, v118, v70
    v_mul_f32 v71, v119, v71
    s_waitcnt vmcnt(0)
    v_lshlrev_b32 v11, 3, v1
    v_add_u32 v11, 262144, v11
    s_mov_b64 exec, 65535
    buffer_store_dwordx2 v[62:63], v11, s[20:23], s59 offen offset:0 sc1
    s_mov_b64 exec, -1
    v_cmp_ne_u64 vcc, s[80:81], v[28:29]
    s_mov_b32 s89, 0
    s_cbranch_vccnz L_noearly
    s_mul_i32 s3, s84, 84
    s_add_u32 s3, s3, s82
    s_lshl_b32 s3, s3, 10
    buffer_load_dwordx4 v[32:35], v3, s[20:23], s3 offen offset:0 sc1
    buffer_load_dwordx4 v[36:39], v2, s[20:23], s3 offen offset:1024 sc1
    buffer_load_dwordx4 v[40:43], v4, s[20:23], s3 offen offset:2048 sc1
    s_mul_i32 s45, s36, 9216
    s_add_i32 s3, s85, 0
    s_max_i32 s3, s3, 0
    s_mul_i32 s3, s3, 84
    s_add_u32 s3, s3, s82
    s_add_u32 m0, s45, 98304
    s_add_u32 s3, s3, 28
    s_lshl_b32 s3, s3, 10
    buffer_load_dwordx4 v3, s[20:23], s3 offen offset:0 sc1 lds
    buffer_load_dwordx4 v2, s[20:23], s3 offen offset:1024 sc1 lds
    buffer_load_dwordx4 v4, s[20:23], s3 offen offset:2048 sc1 lds
    s_add_i32 s3, s85, 1
    s_max_i32 s3, s3, 0
    s_mul_i32 s3, s3, 84
    s_add_u32 s3, s3, s82
    s_add_u32 m0, s45, 101376
    s_add_u32 s3, s3, 28
    s_lshl_b32 s3, s3, 10
    buffer_load_dwordx4 v3, s[20:23], s3 offen offset:0 sc1 lds
    buffer_load_dwordx4 v2, s[20:23], s3 offen offset:1024 sc1 lds
    buffer_load_dwordx4 v4, s[20:23], s3 offen offset:2048 sc1 lds
    s_add_i32 s3, s85, 2
    s_max_i32 s3, s3, 0
    s_mul_i32 s3, s3, 84
    s_add_u32 s3, s3, s82
    s_add_u32 m0, s45, 104448
    s_add_u32 s3, s3, 28
    s_lshl_b32 s3, s3, 10
    buffer_load_dwordx4 v3, s[20:23], s3 offen offset:0 sc1 lds
    buffer_load_dwordx4 v2, s[20:23], s3 offen offset:1024 sc1 lds
    buffer_load_dwordx4 v4, s[20:23], s3 offen offset:2048 sc1 lds
    s_mov_b32 s89, 1
L_noearly:
    v_cvt_pk_bf16_f32 v64, v64, v65
    v_cvt_pk_bf16_f32 v65, v66, v67
    v_cvt_pk_bf16_f32 v66, v68, v69
    v_cvt_pk_bf16_f32 v67, v70, v71
    buffer_store_dwordx4 v[64:67], v2, s[20:23], s58 offen offset:0 sc1
    v_fma_f32 v72, v104, v18, v72
    v_fma_f32 v73, v105, v18, v73
    v_fma_f32 v74, v106, v18, v74
    v_fma_f32 v75, v107, v18, v75
    v_mul_f32 v120, v22, v72
    v_mul_f32 v121, v22, v73
    v_mul_f32 v122, v22, v74
    v_mul_f32 v123, v22, v75
    v_exp_f32 v120, v120
    v_exp_f32 v121, v121
    v_exp_f32 v122, v122
    v_exp_f32 v123, v123
    v_fma_f32 v120, v120, v23, v23
    v_fma_f32 v121, v121, v23, v23
    v_fma_f32 v122, v122, v23, v23
    v_fma_f32 v123, v123, v23, v23
    v_rcp_f32 v120, v120
    v_rcp_f32 v121, v121
    v_rcp_f32 v122, v122
    v_rcp_f32 v123, v123
    v_mul_f32 v72, v120, v72
    v_mul_f32 v73, v121, v73
    v_mul_f32 v74, v122, v74
    v_mul_f32 v75, v123, v75
    v_fma_f32 v76, v108, v18, v76
    v_fma_f32 v77, v109, v18, v77
    v_fma_f32 v78, v110, v18, v78
    v_fma_f32 v79, v111, v18, v79
    v_mul_f32 v124, v22, v76
    v_mul_f32 v125, v22, v77
    v_mul_f32 v126, v22, v78
    v_mul_f32 v127, v22, v79
    v_exp_f32 v124, v124
    v_exp_f32 v125, v125
    v_exp_f32 v126, v126
    v_exp_f32 v127, v127
    v_fma_f32 v124, v124, v23, v23
    v_fma_f32 v125, v125, v23, v23
    v_fma_f32 v126, v126, v23, v23
    v_fma_f32 v127, v127, v23, v23
    v_rcp_f32 v124, v124
    v_rcp_f32 v125, v125
    v_rcp_f32 v126, v126
    v_rcp_f32 v127, v127
    v_mul_f32 v76, v124, v76
    v_mul_f32 v77, v125, v77
    v_mul_f32 v78, v126, v78
    v_mul_f32 v79, v127, v79
    v_cvt_pk_bf16_f32 v68, v72, v73
    v_cvt_pk_bf16_f32 v69, v74, v75
    v_cvt_pk_bf16_f32 v70, v76, v77
    v_cvt_pk_bf16_f32 v71, v78, v79
    buffer_store_dwordx4 v[68:71], v2, s[20:23], s58 offen offset:1024 sc1
L_att:
    s_setprio 2
    s_mov_b32 s90, s59
    s_cmp_lg_u32 s89, 0
    s_cbranch_scc1 L_kdone
    s_mov_b64 exec, 16383
    s_mov_b32 s47, 0
L_poll_33:
    buffer_load_dwordx2 v[28:29], v5, s[20:23], 0 offen offset:0 sc1
    s_add_u32 s47, s47, 1
    s_waitcnt vmcnt(0)
    v_cmp_ne_u64 vcc, s[80:81], v[28:29]
    s_nop 0
    s_cbranch_vccz L_polle_34
    s_sleep 4
    s_cmp_lt_u32 s47, 200000
    s_cbranch_scc1 L_poll_33
L_polle_34:
    s_mov_b64 exec, -1
    s_cmp_lt_u32 s11, 4
    s_cbranch_scc1 L_nohf0
    v_lshlrev_b32 v11, 3, v1
    v_add_u32 v11, 524288, v11
    s_mov_b64 exec, 65535
    buffer_store_dwordx2 v[62:63], v11, s[20:23], s90 offen offset:0 sc1
    s_mov_b64 exec, -1
L_nohf0:
    s_mul_i32 s3, s84, 84
    s_add_u32 s3, s3, s82
    s_lshl_b32 s3, s3, 10
    buffer_load_dwordx4 v[32:35], v3, s[20:23], s3 offen offset:0 sc1
    buffer_load_dwordx4 v[36:39], v2, s[20:23], s3 offen offset:1024 sc1
    buffer_load_dwordx4 v[40:43], v4, s[20:23], s3 offen offset:2048 sc1
    s_mul_i32 s45, s36, 9216
    s_add_i32 s3, s85, 0
    s_max_i32 s3, s3, 0
    s_mul_i32 s3, s3, 84
    s_add_u32 s3, s3, s82
    s_add_u32 m0, s45, 98304
    s_add_u32 s3, s3, 28
    s_lshl_b32 s3, s3, 10
    buffer_load_dwordx4 v3, s[20:23], s3 offen offset:0 sc1 lds
    buffer_load_dwordx4 v2, s[20:23], s3 offen offset:1024 sc1 lds
    buffer_load_dwordx4 v4, s[20:23], s3 offen offset:2048 sc1 lds
    s_add_i32 s3, s85, 1
    s_max_i32 s3, s3, 0
    s_mul_i32 s3, s3, 84
    s_add_u32 s3, s3, s82
    s_add_u32 m0, s45, 101376
    s_add_u32 s3, s3, 28
    s_lshl_b32 s3, s3, 10
    buffer_load_dwordx4 v3, s[20:23], s3 offen offset:0 sc1 lds
    buffer_load_dwordx4 v2, s[20:23], s3 offen offset:1024 sc1 lds
    buffer_load_dwordx4 v4, s[20:23], s3 offen offset:2048 sc1 lds
    s_add_i32 s3, s85, 2
    s_max_i32 s3, s3, 0
    s_mul_i32 s3, s3, 84
    s_add_u32 s3, s3, s82
    s_add_u32 m0, s45, 104448
    s_add_u32 s3, s3, 28
    s_lshl_b32 s3, s3, 10
    buffer_load_dwordx4 v3, s[20:23], s3 offen offset:0 sc1 lds
    buffer_load_dwordx4 v2, s[20:23], s3 offen offset:1024 sc1 lds
    buffer_load_dwordx4 v4, s[20:23], s3 offen offset:2048 sc1 lds
L_kdone:
    v_lshrrev_b32 v12, 5, v1
    v_lshlrev_b32 v13, 6, v12
    v_xor_b32 v3, v13, v3
    v_xor_b32 v4, v13, v4
    v_xor_b32 v30, v13, v2
    v_xor_b32 v30, 128, v30
    s_mov_b32 s47, 0
L_sp_35:
    ds_read_b32 v11, v7 offset:12
    s_add_u32 s47, s47, 1
    s_waitcnt lgkmcnt(0)
    v_cmp_gt_u32 vcc, 8, v11
    s_nop 0
    s_cbranch_vccz L_spe_36
    s_cmp_lt_u32 s47, 1600000
    s_cbranch_scc1 L_sp_35
L_spe_36:
    s_mul_i32 s45, s36, 9216
    s_add_i32 s3, s85, 0
    s_max_i32 s3, s3, 0
    s_mul_i32 s3, s3, 84
    s_add_u32 s3, s3, s82
    s_add_u32 m0, s45, 49152
    s_add_u32 s3, s3, 56
    s_lshl_b32 s3, s3, 10
    buffer_load_dwordx4 v3, s[20:23], s3 offen offset:0 sc1 lds
    buffer_load_dwordx4 v30, s[20:23], s3 offen offset:1024 sc1 lds
    buffer_load_dwordx4 v4, s[20:23], s3 offen offset:2048 sc1 lds
    s_add_i32 s3, s85, 1
    s_max_i32 s3, s3, 0
    s_mul_i32 s3, s3, 84
    s_add_u32 s3, s3, s82
    s_add_u32 m0, s45, 52224
    s_add_u32 s3, s3, 56
    s_lshl_b32 s3, s3, 10
    buffer_load_dwordx4 v3, s[20:23], s3 offen offset:0 sc1 lds
    buffer_load_dwordx4 v30, s[20:23], s3 offen offset:1024 sc1 lds
    buffer_load_dwordx4 v4, s[20:23], s3 offen offset:2048 sc1 lds
    s_add_i32 s3, s85, 2
    s_max_i32 s3, s3, 0
    s_mul_i32 s3, s3, 84
    s_add_u32 s3, s3, s82
    s_add_u32 m0, s45, 55296
    s_add_u32 s3, s3, 56
    s_lshl_b32 s3, s3, 10
    buffer_load_dwordx4 v3, s[20:23], s3 offen offset:0 sc1 lds
    buffer_load_dwordx4 v30, s[20:23], s3 offen offset:1024 sc1 lds
    buffer_load_dwordx4 v4, s[20:23], s3 offen offset:2048 sc1 lds
    s_waitcnt vmcnt(9)
    s_mov_b64 exec, 1
    v_mov_b32 v11, 1
    ds_add_u32 v7, v11 offset:16
    s_mov_b64 exec, -1
    s_cmp_eq_u32 s89, 0
    s_cbranch_scc1 L_nohf
    v_lshlrev_b32 v11, 3, v1
    v_add_u32 v11, 524288, v11
    s_mov_b64 exec, 65535
    buffer_store_dwordx2 v[62:63], v11, s[20:23], s90 offen offset:0 sc1
    s_mov_b64 exec, -1
L_nohf:
    s_mul_i32 s3, s36, 3072
    s_add_u32 s44, s3, 98304
    v_add_u32 v5, s44, v2
    v_bfe_u32 v14, v1, 4, 1
    v_and_b32 v15, 3, v1
    v_lshl_add_u32 v14, v14, 2, v15
    v_add_u32 v14, s83, v14
    v_lshrrev_b32 v15, 2, v14
    v_and_b32 v16, 1, v14
    v_bfe_u32 v17, v14, 1, 1
    v_bfe_u32 v19, v1, 2, 2
    v_lshl_add_u32 v18, v12, 2, v19
    v_and_b32 v19, 1, v15
    v_lshl_add_u32 v19, v19, 1, v16
    v_lshlrev_b32 v19, 2, v19
    v_xor_b32 v18, v18, v19
    v_lshlrev_b32 v6, 4, v18
    v_lshl_add_u32 v6, v17, 3, v6
    v_lshl_add_u32 v6, v16, 9, v6
    v_lshl_add_u32 v6, v15, 10, v6
    v_xor_b32 v9, 128, v6
    s_add_u32 s3, s3, 49152
    v_add_u32 v6, s3, v6
    v_add_u32 v9, s3, v9
    s_add_u32 s3, s83, 7
    s_lshr_b32 s44, s3, 2
    s_lshl_b32 s44, s44, 10
    s_and_b32 s45, s3, 1
    s_lshl_b32 s45, s45, 9
    s_add_u32 s44, s44, s45
    s_and_b32 s45, s3, 2
    s_lshl_b32 s45, s45, 2
    s_add_u32 s44, s44, s45
    s_mul_i32 s45, s36, 9216
    s_add_u32 s44, s44, s45
    s_add_u32 s44, s44, 49152
    v_and_b32 v56, 31, v1
    v_lshlrev_b32 v56, 4, v56
    v_mul_u32_u24 v57, 3072, v12
    v_add3_u32 v56, v56, v57, s44
    v_mov_b32 v58, 0x3f80
    v_mov_b32 v59, 0
    s_mov_b32 s48, 0xffffffff
    s_mov_b32 s49, 0xfffffff0
    s_mov_b32 s50, 0xfffffffe
    s_mov_b32 s51, 0xffffffe0
    s_mov_b32 s52, 0xfffffffc
    s_mov_b32 s53, 0xffffffc0
    s_mov_b32 s54, 0xfffffff8
    s_mov_b32 s55, 0xffffff80
    s_mov_b32 s56, 0xffffff00
    s_mov_b32 s57, 0xfffff000
    s_mov_b32 s58, 0xfffffe00
    s_mov_b32 s59, 0xffffe000
    s_mov_b32 s60, 0xfffffc00
    s_mov_b32 s61, 0xffffc000
    s_mov_b32 s62, 0xfffff800
    s_mov_b32 s63, 0xffff8000
    s_mov_b32 s64, 0xffff0000
    s_mov_b32 s65, 0xfff00000
    s_mov_b32 s66, 0xfffe0000
    s_mov_b32 s67, 0xffe00000
    s_mov_b32 s68, 0xfffc0000
    s_mov_b32 s69, 0xffc00000
    s_mov_b32 s70, 0xfff80000
    s_mov_b32 s71, 0xff800000
    s_mov_b32 s72, 0xff000000
    s_mov_b32 s73, 0xf0000000
    s_mov_b32 s74, 0xfe000000
    s_mov_b32 s75, 0xe0000000
    s_mov_b32 s76, 0xfc000000
    s_mov_b32 s77, 0xc0000000
    s_mov_b32 s78, 0xf8000000
    s_mov_b32 s79, 0x80000000
    v_mov_b32 v14, 0xffff
    v_mov_b32 v15, 0xffff0000
    v_cndmask_b32 v240, 0, v14, s[48:49]
    v_cndmask_b32 v16, 0, v15, s[50:51]
    v_or_b32 v240, v240, v16
    v_cndmask_b32 v241, 0, v14, s[52:53]
    v_cndmask_b32 v16, 0, v15, s[54:55]
    v_or_b32 v241, v241, v16
    v_cndmask_b32 v242, 0, v14, s[56:57]
    v_cndmask_b32 v16, 0, v15, s[58:59]
    v_or_b32 v242, v242, v16
    v_cndmask_b32 v243, 0, v14, s[60:61]
    v_cndmask_b32 v16, 0, v15, s[62:63]
    v_or_b32 v243, v243, v16
    v_cndmask_b32 v244, 0, v14, s[64:65]
    v_cndmask_b32 v16, 0, v15, s[66:67]
    v_or_b32 v244, v244, v16
    v_cndmask_b32 v245, 0, v14, s[68:69]
    v_cndmask_b32 v16, 0, v15, s[70:71]
    v_or_b32 v245, v245, v16
    v_cndmask_b32 v246, 0, v14, s[72:73]
    v_cndmask_b32 v16, 0, v15, s[74:75]
    v_or_b32 v246, v246, v16
    v_cndmask_b32 v247, 0, v14, s[76:77]
    v_cndmask_b32 v16, 0, v15, s[78:79]
    v_or_b32 v247, v247, v16
    v_mov_b32 v24, 0x3f803f80
    v_mov_b32 v25, 0x3f803f80
    v_mov_b32 v26, 0x3f803f80
    v_mov_b32 v27, 0x3f803f80
    v_mov_b32 v29, 0
    v_mov_b32 v30, 0
    v_mov_b32 v31, 0
    v_subrev_u32 v12, s83, v12
    v_add_u32 v13, 0, v12
    v_cmp_gt_u32 vcc, 7, v13
    s_nop 1
    v_cndmask_b32 v32, 0, v32, vcc
    v_cndmask_b32 v33, 0, v33, vcc
    v_add_u32 v13, 2, v12
    v_cmp_gt_u32 vcc, 7, v13
    s_nop 1
    v_cndmask_b32 v34, 0, v34, vcc
    v_cndmask_b32 v35, 0, v35, vcc
    v_add_u32 v13, 4, v12
    v_cmp_gt_u32 vcc, 7, v13
    s_nop 1
    v_cndmask_b32 v36, 0, v36, vcc
    v_cndmask_b32 v37, 0, v37, vcc
    v_add_u32 v13, 6, v12
    v_cmp_gt_u32 vcc, 7, v13
    s_nop 1
    v_cndmask_b32 v38, 0, v38, vcc
    v_cndmask_b32 v39, 0, v39, vcc
    v_add_u32 v13, 8, v12
    v_cmp_gt_u32 vcc, 7, v13
    s_nop 1
    v_cndmask_b32 v40, 0, v40, vcc
    v_cndmask_b32 v41, 0, v41, vcc
    v_add_u32 v13, 10, v12
    v_cmp_gt_u32 vcc, 7, v13
    s_nop 1
    v_cndmask_b32 v42, 0, v42, vcc
    v_cndmask_b32 v43, 0, v43, vcc
    s_mov_b32 s47, 0
L_sp_37:
    ds_read_b32 v11, v7 offset:16
    s_add_u32 s47, s47, 1
    s_waitcnt lgkmcnt(0)
    v_cmp_gt_u32 vcc, 4, v11
    s_nop 0
    s_cbranch_vccz L_spe_38
    s_cmp_lt_u32 s47, 1600000
    s_cbranch_scc1 L_sp_37
L_spe_38:
    ds_read_b128 v[44:47], v5 offset:24576
    ds_read_b128 v[48:51], v5 offset:25600
    ds_read_b128 v[52:55], v5 offset:26624
    s_waitcnt lgkmcnt(0)
    v_mfma_f32_32x32x16_bf16 v[176:191], v[44:47], v[32:35], 0
    ds_read_b128 v[12:15], v5 offset:0
    v_mfma_f32_32x32x16_bf16 v[176:191], v[48:51], v[36:39], v[176:191]
    ds_read_b128 v[16:19], v5 offset:1024
    v_mfma_f32_32x32x16_bf16 v[176:191], v[52:55], v[40:43], v[176:191]
    ds_read_b128 v[20:23], v5 offset:2048
    s_waitcnt lgkmcnt(0)
    v_mfma_f32_32x32x16_bf16 v[192:207], v[12:15], v[32:35], 0
    ds_read_b128 v[44:47], v5 offset:3072
    v_mfma_f32_32x32x16_bf16 v[192:207], v[16:19], v[36:39], v[192:207]
    ds_read_b128 v[48:51], v5 offset:4096
    v_mfma_f32_32x32x16_bf16 v[192:207], v[20:23], v[40:43], v[192:207]
    ds_read_b128 v[52:55], v5 offset:5120
    s_waitcnt lgkmcnt(0)
    v_mfma_f32_32x32x16_bf16 v[64:79], v[44:47], v[32:35], 0
    ds_read_b128 v[12:15], v5 offset:6144
    v_mfma_f32_32x32x16_bf16 v[64:79], v[48:51], v[36:39], v[64:79]
    ds_read_b128 v[16:19], v5 offset:7168
    v_mfma_f32_32x32x16_bf16 v[64:79], v[52:55], v[40:43], v[64:79]
    ds_read_b128 v[20:23], v5 offset:8192
    s_waitcnt lgkmcnt(0)
    v_mfma_f32_32x32x16_bf16 v[80:95], v[12:15], v[32:35], 0
    ds_read_b128 v[44:47], v5 offset:9216
    ds_read_b128 v[48:51], v5 offset:10240
    ds_read_b128 v[52:55], v5 offset:11264
    v_cndmask_b32 v176, v192, v176, s[48:49]
    v_cndmask_b32 v177, v193, v177, s[50:51]
    v_mfma_f32_32x32x16_bf16 v[80:95], v[16:19], v[36:39], v[80:95]
    v_cndmask_b32 v178, v194, v178, s[52:53]
    v_cndmask_b32 v179, v195, v179, s[54:55]
    v_cndmask_b32 v180, v196, v180, s[56:57]
    v_cndmask_b32 v181, v197, v181, s[58:59]
    v_cndmask_b32 v182, v198, v182, s[60:61]
    v_mfma_f32_32x32x16_bf16 v[80:95], v[20:23], v[40:43], v[80:95]
    v_cndmask_b32 v183, v199, v183, s[62:63]
    v_cndmask_b32 v184, v200, v184, s[64:65]
    v_cndmask_b32 v185, v201, v185, s[66:67]
    v_cndmask_b32 v186, v202, v186, s[68:69]
    v_cndmask_b32 v187, v203, v187, s[70:71]
    s_waitcnt lgkmcnt(0)
    v_mfma_f32_32x32x16_bf16 v[96:111], v[44:47], v[32:35], 0
    ds_read_b128 v[12:15], v5 offset:12288
    ds_read_b128 v[16:19], v5 offset:13312
    ds_read_b128 v[20:23], v5 offset:14336
    v_cndmask_b32 v188, v204, v188, s[72:73]
    v_cndmask_b32 v189, v205, v189, s[74:75]
    v_mfma_f32_32x32x16_bf16 v[96:111], v[48:51], v[36:39], v[96:111]
    v_cndmask_b32 v190, v206, v190, s[76:77]
    v_cndmask_b32 v191, v207, v191, s[78:79]
    v_max_f32 v224, v176, v180
    v_max_f32 v225, v177, v181
    v_max_f32 v226, v178, v182
    v_mfma_f32_32x32x16_bf16 v[96:111], v[52:55], v[40:43], v[96:111]
    v_max_f32 v227, v179, v183
    v_max3_f32 v224, v224, v184, v188
    v_max3_f32 v225, v225, v185, v189
    v_max3_f32 v226, v226, v186, v190
    v_max3_f32 v227, v227, v187, v191
    s_waitcnt lgkmcnt(0)
    v_mfma_f32_32x32x16_bf16 v[112:127], v[12:15], v[32:35], 0
    ds_read_b128 v[44:47], v5 offset:15360
    ds_read_b128 v[48:51], v5 offset:16384
    ds_read_b128 v[52:55], v5 offset:17408
    v_max3_f32 v224, v224, v64, v68
    v_max3_f32 v225, v225, v65, v69
    v_mfma_f32_32x32x16_bf16 v[112:127], v[16:19], v[36:39], v[112:127]
    v_max3_f32 v226, v226, v66, v70
    v_max3_f32 v227, v227, v67, v71
    v_max3_f32 v224, v224, v72, v76
    v_max3_f32 v225, v225, v73, v77
    v_max3_f32 v226, v226, v74, v78
    v_mfma_f32_32x32x16_bf16 v[112:127], v[20:23], v[40:43], v[112:127]
    v_max3_f32 v227, v227, v75, v79
    v_max3_f32 v224, v224, v80, v84
    v_max3_f32 v225, v225, v81, v85
    v_max3_f32 v226, v226, v82, v86
    v_max3_f32 v227, v227, v83, v87
    s_waitcnt lgkmcnt(0)
    v_mfma_f32_32x32x16_bf16 v[128:143], v[44:47], v[32:35], 0
    ds_read_b128 v[12:15], v5 offset:18432
    ds_read_b128 v[16:19], v5 offset:19456
    ds_read_b128 v[20:23], v5 offset:20480
    v_max3_f32 v224, v224, v88, v92
    v_max3_f32 v225, v225, v89, v93
    v_mfma_f32_32x32x16_bf16 v[128:143], v[48:51], v[36:39], v[128:143]
    v_max3_f32 v226, v226, v90, v94
    v_max3_f32 v227, v227, v91, v95
    v_max3_f32 v224, v224, v96, v100
    v_max3_f32 v225, v225, v97, v101
    v_max3_f32 v226, v226, v98, v102
    v_mfma_f32_32x32x16_bf16 v[128:143], v[52:55], v[40:43], v[128:143]
    v_max3_f32 v227, v227, v99, v103
    v_max3_f32 v224, v224, v104, v108
    v_max3_f32 v225, v225, v105, v109
    v_max3_f32 v226, v226, v106, v110
    v_max3_f32 v227, v227, v107, v111
    s_waitcnt lgkmcnt(0)
    v_mfma_f32_32x32x16_bf16 v[144:159], v[12:15], v[32:35], 0
    ds_read_b128 v[44:47], v5 offset:21504
    ds_read_b128 v[48:51], v5 offset:22528
    ds_read_b128 v[52:55], v5 offset:23552
    v_max3_f32 v224, v224, v112, v116
    v_mfma_f32_32x32x16_bf16 v[144:159], v[16:19], v[36:39], v[144:159]
    v_max3_f32 v225, v225, v113, v117
    v_max3_f32 v226, v226, v114, v118
    v_max3_f32 v227, v227, v115, v119
    v_mfma_f32_32x32x16_bf16 v[144:159], v[20:23], v[40:43], v[144:159]
    v_max3_f32 v224, v224, v120, v124
    v_max3_f32 v225, v225, v121, v125
    v_max3_f32 v226, v226, v122, v126
    v_max3_f32 v227, v227, v123, v127
    s_waitcnt lgkmcnt(0)
    v_mfma_f32_32x32x16_bf16 v[160:175], v[44:47], v[32:35], 0
    v_max3_f32 v224, v224, v128, v132
    v_max3_f32 v225, v225, v129, v133
    v_max3_f32 v226, v226, v130, v134
    v_mfma_f32_32x32x16_bf16 v[160:175], v[48:51], v[36:39], v[160:175]
    v_max3_f32 v227, v227, v131, v135
    v_max3_f32 v224, v224, v136, v140
    v_mfma_f32_32x32x16_bf16 v[160:175], v[52:55], v[40:43], v[160:175]
    v_max3_f32 v225, v225, v137, v141
    v_max3_f32 v226, v226, v138, v142
    v_max3_f32 v227, v227, v139, v143
    v_max3_f32 v224, v224, v144, v148
    v_max3_f32 v225, v225, v145, v149
    v_max3_f32 v226, v226, v146, v150
    v_max3_f32 v227, v227, v147, v151
    v_max3_f32 v224, v224, v152, v156
    v_max3_f32 v225, v225, v153, v157
    v_max3_f32 v226, v226, v154, v158
    v_max3_f32 v227, v227, v155, v159
    s_waitcnt vmcnt(0)
    ds_write_b64 v56, v[58:59]
    ds_write_b64 v56, v[58:59] offset:3072
    s_mov_b64 exec, 1
    v_mov_b32 v11, 1
    ds_add_u32 v7, v11 offset:16
    s_mov_b64 exec, -1
    v_max3_f32 v224, v224, v160, v164
    v_max3_f32 v225, v225, v161, v165
    v_max3_f32 v226, v226, v162, v166
    v_max3_f32 v227, v227, v163, v167
    v_max3_f32 v224, v224, v168, v172
    v_max3_f32 v225, v225, v169, v173
    v_max3_f32 v226, v226, v170, v174
    v_max3_f32 v227, v227, v171, v175
    s_cmp_ge_u32 s84, 8
    s_cbranch_scc1 L_valid
    v_mov_b32 v12, 0xf149f2ca
    v_cndmask_b32 v176, v12, v176, s[48:49]
    v_cndmask_b32 v177, v12, v177, s[50:51]
    v_cndmask_b32 v178, v12, v178, s[52:53]
    v_cndmask_b32 v179, v12, v179, s[54:55]
    v_cndmask_b32 v180, v12, v180, s[56:57]
    v_cndmask_b32 v181, v12, v181, s[58:59]
    v_cndmask_b32 v182, v12, v182, s[60:61]
    v_cndmask_b32 v183, v12, v183, s[62:63]
    v_cndmask_b32 v184, v12, v184, s[64:65]
    v_cndmask_b32 v185, v12, v185, s[66:67]
    v_cndmask_b32 v186, v12, v186, s[68:69]
    v_cndmask_b32 v187, v12, v187, s[70:71]
    v_cndmask_b32 v188, v12, v188, s[72:73]
    v_cndmask_b32 v189, v12, v189, s[74:75]
    v_cndmask_b32 v190, v12, v190, s[76:77]
    v_cndmask_b32 v191, v12, v191, s[78:79]
    s_cmp_ge_u32 s84, 7
    s_cbranch_scc1 L_remax
    v_mov_b32 v64, v12
    v_mov_b32 v65, v12
    v_mov_b32 v66, v12
    v_mov_b32 v67, v12
    v_mov_b32 v68, v12
    v_mov_b32 v69, v12
    v_mov_b32 v70, v12
    v_mov_b32 v71, v12
    v_mov_b32 v72, v12
    v_mov_b32 v73, v12
    v_mov_b32 v74, v12
    v_mov_b32 v75, v12
    v_mov_b32 v76, v12
    v_mov_b32 v77, v12
    v_mov_b32 v78, v12
    v_mov_b32 v79, v12
    s_cmp_ge_u32 s84, 6
    s_cbranch_scc1 L_remax
    v_mov_b32 v80, v12
    v_mov_b32 v81, v12
    v_mov_b32 v82, v12
    v_mov_b32 v83, v12
    v_mov_b32 v84, v12
    v_mov_b32 v85, v12
    v_mov_b32 v86, v12
    v_mov_b32 v87, v12
    v_mov_b32 v88, v12
    v_mov_b32 v89, v12
    v_mov_b32 v90, v12
    v_mov_b32 v91, v12
    v_mov_b32 v92, v12
    v_mov_b32 v93, v12
    v_mov_b32 v94, v12
    v_mov_b32 v95, v12
    s_cmp_ge_u32 s84, 5
    s_cbranch_scc1 L_remax
    v_mov_b32 v96, v12
    v_mov_b32 v97, v12
    v_mov_b32 v98, v12
    v_mov_b32 v99, v12
    v_mov_b32 v100, v12
    v_mov_b32 v101, v12
    v_mov_b32 v102, v12
    v_mov_b32 v103, v12
    v_mov_b32 v104, v12
    v_mov_b32 v105, v12
    v_mov_b32 v106, v12
    v_mov_b32 v107, v12
    v_mov_b32 v108, v12
    v_mov_b32 v109, v12
    v_mov_b32 v110, v12
    v_mov_b32 v111, v12
    s_cmp_ge_u32 s84, 4
    s_cbranch_scc1 L_remax
    v_mov_b32 v112, v12
    v_mov_b32 v113, v12
    v_mov_b32 v114, v12
    v_mov_b32 v115, v12
    v_mov_b32 v116, v12
    v_mov_b32 v117, v12
    v_mov_b32 v118, v12
    v_mov_b32 v119, v12
    v_mov_b32 v120, v12
    v_mov_b32 v121, v12
    v_mov_b32 v122, v12
    v_mov_b32 v123, v12
    v_mov_b32 v124, v12
    v_mov_b32 v125, v12
    v_mov_b32 v126, v12
    v_mov_b32 v127, v12
    s_cmp_ge_u32 s84, 3
    s_cbranch_scc1 L_remax
    v_mov_b32 v128, v12
    v_mov_b32 v129, v12
    v_mov_b32 v130, v12
    v_mov_b32 v131, v12
    v_mov_b32 v132, v12
    v_mov_b32 v133, v12
    v_mov_b32 v134, v12
    v_mov_b32 v135, v12
    v_mov_b32 v136, v12
    v_mov_b32 v137, v12
    v_mov_b32 v138, v12
    v_mov_b32 v139, v12
    v_mov_b32 v140, v12
    v_mov_b32 v141, v12
    v_mov_b32 v142, v12
    v_mov_b32 v143, v12
    s_cmp_ge_u32 s84, 2
    s_cbranch_scc1 L_remax
    v_mov_b32 v144, v12
    v_mov_b32 v145, v12
    v_mov_b32 v146, v12
    v_mov_b32 v147, v12
    v_mov_b32 v148, v12
    v_mov_b32 v149, v12
    v_mov_b32 v150, v12
    v_mov_b32 v151, v12
    v_mov_b32 v152, v12
    v_mov_b32 v153, v12
    v_mov_b32 v154, v12
    v_mov_b32 v155, v12
    v_mov_b32 v156, v12
    v_mov_b32 v157, v12
    v_mov_b32 v158, v12
    v_mov_b32 v159, v12
    s_cmp_ge_u32 s84, 1
    s_cbranch_scc1 L_remax
    v_mov_b32 v160, v12
    v_mov_b32 v161, v12
    v_mov_b32 v162, v12
    v_mov_b32 v163, v12
    v_mov_b32 v164, v12
    v_mov_b32 v165, v12
    v_mov_b32 v166, v12
    v_mov_b32 v167, v12
    v_mov_b32 v168, v12
    v_mov_b32 v169, v12
    v_mov_b32 v170, v12
    v_mov_b32 v171, v12
    v_mov_b32 v172, v12
    v_mov_b32 v173, v12
    v_mov_b32 v174, v12
    v_mov_b32 v175, v12
L_remax:
    v_max_f32 v224, v176, v180
    v_max_f32 v225, v177, v181
    v_max_f32 v226, v178, v182
    v_max_f32 v227, v179, v183
    v_max3_f32 v224, v224, v184, v188
    v_max3_f32 v225, v225, v185, v189
    v_max3_f32 v226, v226, v186, v190
    v_max3_f32 v227, v227, v187, v191
    v_max3_f32 v224, v224, v64, v68
    v_max3_f32 v225, v225, v65, v69
    v_max3_f32 v226, v226, v66, v70
    v_max3_f32 v227, v227, v67, v71
    v_max3_f32 v224, v224, v72, v76
    v_max3_f32 v225, v225, v73, v77
    v_max3_f32 v226, v226, v74, v78
    v_max3_f32 v227, v227, v75, v79
    v_max3_f32 v224, v224, v80, v84
    v_max3_f32 v225, v225, v81, v85
    v_max3_f32 v226, v226, v82, v86
    v_max3_f32 v227, v227, v83, v87
    v_max3_f32 v224, v224, v88, v92
    v_max3_f32 v225, v225, v89, v93
    v_max3_f32 v226, v226, v90, v94
    v_max3_f32 v227, v227, v91, v95
    v_max3_f32 v224, v224, v96, v100
    v_max3_f32 v225, v225, v97, v101
    v_max3_f32 v226, v226, v98, v102
    v_max3_f32 v227, v227, v99, v103
    v_max3_f32 v224, v224, v104, v108
    v_max3_f32 v225, v225, v105, v109
    v_max3_f32 v226, v226, v106, v110
    v_max3_f32 v227, v227, v107, v111
    v_max3_f32 v224, v224, v112, v116
    v_max3_f32 v225, v225, v113, v117
    v_max3_f32 v226, v226, v114, v118
    v_max3_f32 v227, v227, v115, v119
    v_max3_f32 v224, v224, v120, v124
    v_max3_f32 v225, v225, v121, v125
    v_max3_f32 v226, v226, v122, v126
    v_max3_f32 v227, v227, v123, v127
    v_max3_f32 v224, v224, v128, v132
    v_max3_f32 v225, v225, v129, v133
    v_max3_f32 v226, v226, v130, v134
    v_max3_f32 v227, v227, v131, v135
    v_max3_f32 v224, v224, v136, v140
    v_max3_f32 v225, v225, v137, v141
    v_max3_f32 v226, v226, v138, v142
    v_max3_f32 v227, v227, v139, v143
    v_max3_f32 v224, v224, v144, v148
    v_max3_f32 v225, v225, v145, v149
    v_max3_f32 v226, v226, v146, v150
    v_max3_f32 v227, v227, v147, v151
    v_max3_f32 v224, v224, v152, v156
    v_max3_f32 v225, v225, v153, v157
    v_max3_f32 v226, v226, v154, v158
    v_max3_f32 v227, v227, v155, v159
    v_max3_f32 v224, v224, v160, v164
    v_max3_f32 v225, v225, v161, v165
    v_max3_f32 v226, v226, v162, v166
    v_max3_f32 v227, v227, v163, v167
    v_max3_f32 v224, v224, v168, v172
    v_max3_f32 v225, v225, v169, v173
    v_max3_f32 v226, v226, v170, v174
    v_max3_f32 v227, v227, v171, v175
L_valid:
    v_max3_f32 v224, v224, v225, v226
    v_max_f32 v224, v224, v227
    v_mov_b32 v225, v224
    v_cmp_gt_u32 vcc, 32, v1
    s_nop 0
    v_permlane32_swap_b32 v224, v225
    v_max_f32 v224, v224, v225
    v_cvt_pk_bf16_f32 v225, 0, v224
    v_sub_f32 v225, v225, v224
    v_cvt_pk_bf16_f32 v225, -v224, v225
    v_cndmask_b32 v28, 0, v225, vcc
    s_nop 1
    v_mfma_f32_32x32x16_bf16 v[64:79], v[24:27], v[28:31], v[64:79]
    v_mfma_f32_32x32x16_bf16 v[80:95], v[24:27], v[28:31], v[80:95]
    s_mov_b32 s47, 0
L_sp_39:
    ds_read_b32 v11, v7 offset:16
    s_add_u32 s47, s47, 1
    s_waitcnt lgkmcnt(0)
    v_cmp_gt_u32 vcc, 8, v11
    s_nop 0
    s_cbranch_vccz L_spe_40
    s_cmp_lt_u32 s47, 1600000
    s_cbranch_scc1 L_sp_39
L_spe_40:
    ds_read_b64_tr_b16 v[44:45], v6 offset:3072
    ds_read_b64_tr_b16 v[46:47], v9 offset:3072
    ds_read_b64_tr_b16 v[48:49], v6 offset:3328
    ds_read_b64_tr_b16 v[50:51], v9 offset:3328
    v_mfma_f32_32x32x16_bf16 v[96:111], v[24:27], v[28:31], v[96:111]
    v_exp_f32 v64, v64
    v_exp_f32 v65, v65
    v_exp_f32 v66, v66
    v_exp_f32 v67, v67
    v_exp_f32 v68, v68
    v_exp_f32 v69, v69
    v_exp_f32 v70, v70
    v_exp_f32 v71, v71
    v_cvt_pk_bf16_f32 v64, v64, v65
    v_cvt_pk_bf16_f32 v65, v66, v67
    v_exp_f32 v72, v72
    v_exp_f32 v73, v73
    v_exp_f32 v74, v74
    v_exp_f32 v75, v75
    v_cvt_pk_bf16_f32 v66, v68, v69
    v_cvt_pk_bf16_f32 v67, v70, v71
    v_exp_f32 v76, v76
    v_exp_f32 v77, v77
    v_exp_f32 v78, v78
    v_exp_f32 v79, v79
    v_cvt_pk_bf16_f32 v68, v72, v73
    v_cvt_pk_bf16_f32 v69, v74, v75
    v_cvt_pk_bf16_f32 v70, v76, v77
    v_cvt_pk_bf16_f32 v71, v78, v79
    s_waitcnt lgkmcnt(0)
    v_mfma_f32_32x32x16_bf16 v[192:207], v[44:47], v[64:67], 0
    ds_read_b64_tr_b16 v[12:13], v6 offset:6144
    ds_read_b64_tr_b16 v[14:15], v9 offset:6144
    ds_read_b64_tr_b16 v[16:17], v6 offset:6400
    ds_read_b64_tr_b16 v[18:19], v9 offset:6400
    v_exp_f32 v80, v80
    v_exp_f32 v81, v81
    v_exp_f32 v82, v82
    v_exp_f32 v83, v83
    v_exp_f32 v84, v84
    v_mfma_f32_32x32x16_bf16 v[192:207], v[48:51], v[68:71], v[192:207]
    v_exp_f32 v85, v85
    v_exp_f32 v86, v86
    v_exp_f32 v87, v87
    v_cvt_pk_bf16_f32 v80, v80, v81
    v_cvt_pk_bf16_f32 v81, v82, v83
    v_exp_f32 v88, v88
    v_exp_f32 v89, v89
    v_exp_f32 v90, v90
    v_exp_f32 v91, v91
    v_mfma_f32_32x32x16_bf16 v[112:127], v[24:27], v[28:31], v[112:127]
    v_cvt_pk_bf16_f32 v82, v84, v85
    v_cvt_pk_bf16_f32 v83, v86, v87
    v_exp_f32 v92, v92
    v_exp_f32 v93, v93
    v_exp_f32 v94, v94
    v_exp_f32 v95, v95
    v_cvt_pk_bf16_f32 v84, v88, v89
    v_cvt_pk_bf16_f32 v85, v90, v91
    v_cvt_pk_bf16_f32 v86, v92, v93
    v_cvt_pk_bf16_f32 v87, v94, v95
    s_waitcnt lgkmcnt(0)
    v_mfma_f32_32x32x16_bf16 v[192:207], v[12:15], v[80:83], v[192:207]
    ds_read_b64_tr_b16 v[44:45], v6 offset:9216
    ds_read_b64_tr_b16 v[46:47], v9 offset:9216
    ds_read_b64_tr_b16 v[48:49], v6 offset:9472
    ds_read_b64_tr_b16 v[50:51], v9 offset:9472
    v_exp_f32 v96, v96
    v_exp_f32 v97, v97
    v_exp_f32 v98, v98
    v_exp_f32 v99, v99
    v_exp_f32 v100, v100
    v_mfma_f32_32x32x16_bf16 v[192:207], v[16:19], v[84:87], v[192:207]
    v_exp_f32 v101, v101
    v_exp_f32 v102, v102
    v_exp_f32 v103, v103
    v_cvt_pk_bf16_f32 v96, v96, v97
    v_cvt_pk_bf16_f32 v97, v98, v99
    v_exp_f32 v104, v104
    v_exp_f32 v105, v105
    v_exp_f32 v106, v106
    v_exp_f32 v107, v107
    v_mfma_f32_32x32x16_bf16 v[128:143], v[24:27], v[28:31], v[128:143]
    v_cvt_pk_bf16_f32 v98, v100, v101
    v_cvt_pk_bf16_f32 v99, v102, v103
    v_exp_f32 v108, v108
    v_exp_f32 v109, v109
    v_exp_f32 v110, v110
    v_exp_f32 v111, v111
    v_cvt_pk_bf16_f32 v100, v104, v105
    v_cvt_pk_bf16_f32 v101, v106, v107
    v_cvt_pk_bf16_f32 v102, v108, v109
    v_cvt_pk_bf16_f32 v103, v110, v111
    s_waitcnt lgkmcnt(0)
    v_mfma_f32_32x32x16_bf16 v[192:207], v[44:47], v[96:99], v[192:207]
    ds_read_b64_tr_b16 v[12:13], v6 offset:12288
    ds_read_b64_tr_b16 v[14:15], v9 offset:12288
    ds_read_b64_tr_b16 v[16:17], v6 offset:12544
    ds_read_b64_tr_b16 v[18:19], v9 offset:12544
    v_exp_f32 v112, v112
    v_exp_f32 v113, v113
    v_exp_f32 v114, v114
    v_exp_f32 v115, v115
    v_exp_f32 v116, v116
    v_mfma_f32_32x32x16_bf16 v[192:207], v[48:51], v[100:103], v[192:207]
    v_exp_f32 v117, v117
    v_exp_f32 v118, v118
    v_exp_f32 v119, v119
    v_cvt_pk_bf16_f32 v112, v112, v113
    v_cvt_pk_bf16_f32 v113, v114, v115
    v_exp_f32 v120, v120
    v_exp_f32 v121, v121
    v_exp_f32 v122, v122
    v_exp_f32 v123, v123
    v_mfma_f32_32x32x16_bf16 v[144:159], v[24:27], v[28:31], v[144:159]
    v_cvt_pk_bf16_f32 v114, v116, v117
    v_cvt_pk_bf16_f32 v115, v118, v119
    v_exp_f32 v124, v124
    v_exp_f32 v125, v125
    v_exp_f32 v126, v126
    v_exp_f32 v127, v127
    v_cvt_pk_bf16_f32 v116, v120, v121
    v_cvt_pk_bf16_f32 v117, v122, v123
    v_cvt_pk_bf16_f32 v118, v124, v125
    v_cvt_pk_bf16_f32 v119, v126, v127
    s_waitcnt lgkmcnt(0)
    v_mfma_f32_32x32x16_bf16 v[192:207], v[12:15], v[112:115], v[192:207]
    ds_read_b64_tr_b16 v[44:45], v6 offset:15360
    ds_read_b64_tr_b16 v[46:47], v9 offset:15360
    ds_read_b64_tr_b16 v[48:49], v6 offset:15616
    ds_read_b64_tr_b16 v[50:51], v9 offset:15616
    v_exp_f32 v128, v128
    v_exp_f32 v129, v129
    v_exp_f32 v130, v130
    v_exp_f32 v131, v131
    v_exp_f32 v132, v132
    v_mfma_f32_32x32x16_bf16 v[192:207], v[16:19], v[116:119], v[192:207]
    v_exp_f32 v133, v133
    v_exp_f32 v134, v134
    v_exp_f32 v135, v135
    v_cvt_pk_bf16_f32 v128, v128, v129
    v_cvt_pk_bf16_f32 v129, v130, v131
    v_exp_f32 v136, v136
    v_exp_f32 v137, v137
    v_exp_f32 v138, v138
    v_exp_f32 v139, v139
    v_mfma_f32_32x32x16_bf16 v[160:175], v[24:27], v[28:31], v[160:175]
    v_cvt_pk_bf16_f32 v130, v132, v133
    v_cvt_pk_bf16_f32 v131, v134, v135
    v_exp_f32 v140, v140
    v_exp_f32 v141, v141
    v_exp_f32 v142, v142
    v_exp_f32 v143, v143
    v_cvt_pk_bf16_f32 v132, v136, v137
    v_cvt_pk_bf16_f32 v133, v138, v139
    v_cvt_pk_bf16_f32 v134, v140, v141
    v_cvt_pk_bf16_f32 v135, v142, v143
    s_waitcnt lgkmcnt(0)
    v_mfma_f32_32x32x16_bf16 v[192:207], v[44:47], v[128:131], v[192:207]
    ds_read_b64_tr_b16 v[12:13], v6 offset:18432
    ds_read_b64_tr_b16 v[14:15], v9 offset:18432
    ds_read_b64_tr_b16 v[16:17], v6 offset:18688
    ds_read_b64_tr_b16 v[18:19], v9 offset:18688
    v_exp_f32 v144, v144
    v_exp_f32 v145, v145
    v_exp_f32 v146, v146
    v_exp_f32 v147, v147
    v_exp_f32 v148, v148
    v_mfma_f32_32x32x16_bf16 v[192:207], v[48:51], v[132:135], v[192:207]
    v_exp_f32 v149, v149
    v_exp_f32 v150, v150
    v_exp_f32 v151, v151
    v_cvt_pk_bf16_f32 v144, v144, v145
    v_cvt_pk_bf16_f32 v145, v146, v147
    v_exp_f32 v152, v152
    v_exp_f32 v153, v153
    v_exp_f32 v154, v154
    v_exp_f32 v155, v155
    v_mfma_f32_32x32x16_bf16 v[176:191], v[24:27], v[28:31], v[176:191]
    v_cvt_pk_bf16_f32 v146, v148, v149
    v_cvt_pk_bf16_f32 v147, v150, v151
    v_exp_f32 v156, v156
    v_exp_f32 v157, v157
    v_exp_f32 v158, v158
    v_exp_f32 v159, v159
    v_cvt_pk_bf16_f32 v148, v152, v153
    v_cvt_pk_bf16_f32 v149, v154, v155
    v_cvt_pk_bf16_f32 v150, v156, v157
    v_cvt_pk_bf16_f32 v151, v158, v159
    s_waitcnt lgkmcnt(0)
    v_mfma_f32_32x32x16_bf16 v[192:207], v[12:15], v[144:147], v[192:207]
    ds_read_b64_tr_b16 v[44:45], v6 offset:21504
    ds_read_b64_tr_b16 v[46:47], v9 offset:21504
    ds_read_b64_tr_b16 v[48:49], v6 offset:21760
    ds_read_b64_tr_b16 v[50:51], v9 offset:21760
    v_exp_f32 v160, v160
    v_exp_f32 v161, v161
    v_exp_f32 v162, v162
    v_exp_f32 v163, v163
    v_exp_f32 v164, v164
    v_exp_f32 v165, v165
    v_exp_f32 v166, v166
    v_exp_f32 v167, v167
    v_cvt_pk_bf16_f32 v160, v160, v161
    v_cvt_pk_bf16_f32 v161, v162, v163
    v_mfma_f32_32x32x16_bf16 v[192:207], v[16:19], v[148:151], v[192:207]
    v_exp_f32 v168, v168
    v_exp_f32 v169, v169
    v_exp_f32 v170, v170
    v_exp_f32 v171, v171
    v_cvt_pk_bf16_f32 v162, v164, v165
    v_cvt_pk_bf16_f32 v163, v166, v167
    v_exp_f32 v172, v172
    v_exp_f32 v173, v173
    v_exp_f32 v174, v174
    v_exp_f32 v175, v175
    v_cvt_pk_bf16_f32 v164, v168, v169
    v_cvt_pk_bf16_f32 v165, v170, v171
    v_cvt_pk_bf16_f32 v166, v172, v173
    v_cvt_pk_bf16_f32 v167, v174, v175
    s_waitcnt lgkmcnt(0)
    v_mfma_f32_32x32x16_bf16 v[192:207], v[44:47], v[160:163], v[192:207]
    ds_read_b64_tr_b16 v[12:13], v6 offset:24576
    ds_read_b64_tr_b16 v[14:15], v9 offset:24576
    ds_read_b64_tr_b16 v[16:17], v6 offset:24832
    ds_read_b64_tr_b16 v[18:19], v9 offset:24832
    v_exp_f32 v176, v176
    v_exp_f32 v177, v177
    v_exp_f32 v178, v178
    v_exp_f32 v179, v179
    v_exp_f32 v180, v180
    v_exp_f32 v181, v181
    v_exp_f32 v182, v182
    v_exp_f32 v183, v183
    v_cvt_pk_bf16_f32 v176, v176, v177
    v_cvt_pk_bf16_f32 v177, v178, v179
    v_exp_f32 v184, v184
    v_exp_f32 v185, v185
    v_exp_f32 v186, v186
    v_exp_f32 v187, v187
    v_mfma_f32_32x32x16_bf16 v[192:207], v[48:51], v[164:167], v[192:207]
    v_cvt_pk_bf16_f32 v178, v180, v181
    v_cvt_pk_bf16_f32 v179, v182, v183
    v_exp_f32 v188, v188
    v_exp_f32 v189, v189
    v_exp_f32 v190, v190
    v_exp_f32 v191, v191
    v_cvt_pk_bf16_f32 v180, v184, v185
    v_cvt_pk_bf16_f32 v181, v186, v187
    v_cvt_pk_bf16_f32 v182, v188, v189
    v_cvt_pk_bf16_f32 v183, v190, v191
    v_and_b32 v232, v240, v176
    v_and_b32 v233, v241, v177
    v_and_b32 v234, v242, v178
    v_and_b32 v235, v243, v179
    v_and_b32 v236, v244, v180
    v_and_b32 v237, v245, v181
    v_and_b32 v238, v246, v182
    v_and_b32 v239, v247, v183
    v_bfi_b32 v224, v240, 0, v176
    v_bfi_b32 v225, v241, 0, v177
    v_bfi_b32 v226, v242, 0, v178
    v_bfi_b32 v227, v243, 0, v179
    v_bfi_b32 v228, v244, 0, v180
    v_bfi_b32 v229, v245, 0, v181
    v_bfi_b32 v230, v246, 0, v182
    v_bfi_b32 v231, v247, 0, v183
    s_waitcnt lgkmcnt(0)
    v_mfma_f32_32x32x16_bf16 v[192:207], v[12:15], v[232:235], v[192:207]
    ds_read_b64_tr_b16 v[44:45], v6 offset:0
    ds_read_b64_tr_b16 v[46:47], v9 offset:0
    v_mfma_f32_32x32x16_bf16 v[192:207], v[16:19], v[236:239], v[192:207]
    ds_read_b64_tr_b16 v[48:49], v6 offset:256
    ds_read_b64_tr_b16 v[50:51], v9 offset:256
    s_waitcnt lgkmcnt(0)
    v_mfma_f32_32x32x16_bf16 v[192:207], v[44:47], v[224:227], v[192:207]
    v_mfma_f32_32x32x16_bf16 v[192:207], v[48:51], v[228:231], v[192:207]
    s_mov_b64 exec, 1
    v_mov_b32 v11, 1
    ds_add_u32 v7, v11 offset:16
    s_mov_b64 exec, -1
    s_lshl4_add_u32 s3, s84, s40
    s_lshl_b32 s44, s3, 11
    s_add_u32 s44, s44, 14680064
    s_lshl_b32 s3, s3, 7
    s_add_u32 s48, s3, 16777216
    s_nop 2
    v_mov_b32 v12, v204
    v_mov_b32 v13, v204
    s_nop 1
    v_permlane32_swap_b32 v12, v13
    v_rcp_f32 v12, v13
    v_cmp_gt_u32 vcc, 32, v1
    v_mul_f32 v192, v12, v192
    v_mul_f32 v193, v12, v193
    v_mul_f32 v194, v12, v194
    v_mul_f32 v195, v12, v195
    v_mul_f32 v196, v12, v196
    v_mul_f32 v197, v12, v197
    v_mul_f32 v198, v12, v198
    v_mul_f32 v199, v12, v199
    v_cvt_pk_bf16_f32 v192, v192, v193
    v_cvt_pk_bf16_f32 v193, v194, v195
    v_cvt_pk_bf16_f32 v194, v196, v197
    v_cvt_pk_bf16_f32 v195, v198, v199
    buffer_store_dwordx4 v[192:195], v2, s[20:23], s44 offen offset:0 sc1
    v_mul_f32 v200, v12, v200
    v_mul_f32 v201, v12, v201
    v_mul_f32 v202, v12, v202
    v_mul_f32 v203, v12, v203
    v_mul_f32 v204, v12, v204
    v_mul_f32 v205, v12, v205
    v_mul_f32 v206, v12, v206
    v_mul_f32 v207, v12, v207
    v_cvt_pk_bf16_f32 v196, v200, v201
    v_cvt_pk_bf16_f32 v197, v202, v203
    v_cvt_pk_bf16_f32 v198, v204, v205
    v_cvt_pk_bf16_f32 v199, v206, v207
    v_cndmask_b32 v198, 0, v198, vcc
    v_cndmask_b32 v199, 0, v199, vcc
    buffer_store_dwordx4 v[196:199], v2, s[20:23], s44 offen offset:1024 sc1
    s_cmp_lt_u32 s11, 4
    s_cbranch_scc0 L_cont
    s_waitcnt vmcnt(0)
    v_lshlrev_b32 v11, 3, v1
    s_mov_b64 exec, 65535
    buffer_store_dwordx2 v[62:63], v11, s[20:23], s48 offen offset:0 sc1
    s_mov_b64 exec, -1
    s_endpgm
L_cont:
    s_mov_b32 s24, s8
    s_and_b32 s25, s9, 0xffff
    s_mov_b32 s26, 401408
    s_mov_b32 s27, 0x20000
    v_lshrrev_b32 v12, 3, v1
    v_mul_u32_u24 v3, 896, v12
    v_bfe_u32 v12, v1, 4, 1
    v_lshlrev_b32 v12, 2, v12
    v_and_b32 v13, 7, v1
    v_xor_b32 v12, v12, v13
    v_lshl_add_u32 v3, v12, 4, v3
    s_lshl_b32 s3, s43, 7
    v_add_u32 v3, s3, v3
    s_mov_b32 s47, 0
L_sp_41:
    ds_read_b32 v11, v7 offset:16
    s_add_u32 s47, s47, 1
    s_waitcnt lgkmcnt(0)
    v_cmp_gt_u32 vcc, 12, v11
    s_nop 0
    s_cbranch_vccz L_spe_42
    s_cmp_lt_u32 s47, 1600000
    s_cbranch_scc1 L_sp_41
L_spe_42:
    s_setprio 2
    s_mul_i32 s45, s87, 49152
    s_lshl_b32 s3, s86, 10
    s_add_u32 s45, s45, s3
    s_mul_i32 s44, s87, 200704
    s_mul_i32 s3, s86, 7168
    s_add_u32 s44, s44, s3
    s_add_u32 m0, s45, 49152
    s_add_u32 s3, s44, 0
    buffer_load_dwordx4 v3, s[24:27], s3 offen lds
    s_add_u32 m0, s45, 51200
    s_add_u32 s3, s44, 14336
    buffer_load_dwordx4 v3, s[24:27], s3 offen lds
    s_add_u32 m0, s45, 53248
    s_add_u32 s3, s44, 28672
    buffer_load_dwordx4 v3, s[24:27], s3 offen lds
    s_add_u32 m0, s45, 55296
    s_add_u32 s3, s44, 43008
    buffer_load_dwordx4 v3, s[24:27], s3 offen lds
    s_add_u32 m0, s45, 57344
    s_add_u32 s3, s44, 57344
    buffer_load_dwordx4 v3, s[24:27], s3 offen lds
    s_add_u32 m0, s45, 59392
    s_add_u32 s3, s44, 71680
    buffer_load_dwordx4 v3, s[24:27], s3 offen lds
    s_add_u32 m0, s45, 61440
    s_add_u32 s3, s44, 86016
    buffer_load_dwordx4 v3, s[24:27], s3 offen lds
    s_add_u32 m0, s45, 63488
    s_add_u32 s3, s44, 100352
    buffer_load_dwordx4 v3, s[24:27], s3 offen lds
    s_add_u32 m0, s45, 65536
    s_add_u32 s3, s44, 114688
    buffer_load_dwordx4 v3, s[24:27], s3 offen lds
    s_add_u32 m0, s45, 67584
    s_add_u32 s3, s44, 129024
    buffer_load_dwordx4 v3, s[24:27], s3 offen lds
    s_waitcnt vmcnt(10)
    v_lshlrev_b32 v11, 3, v1
    s_mov_b64 exec, 65535
    buffer_store_dwordx2 v[62:63], v11, s[20:23], s48 offen offset:0 sc1
    s_mov_b64 exec, -1
    s_add_u32 m0, s45, 69632
    s_add_u32 s3, s44, 143360
    buffer_load_dwordx4 v3, s[24:27], s3 offen lds
    s_add_u32 m0, s45, 71680
    s_add_u32 s3, s44, 157696
    buffer_load_dwordx4 v3, s[24:27], s3 offen lds
    s_add_u32 m0, s45, 73728
    s_add_u32 s3, s44, 172032
    buffer_load_dwordx4 v3, s[24:27], s3 offen lds
    s_add_u32 m0, s45, 75776
    s_add_u32 s3, s44, 186368
    buffer_load_dwordx4 v3, s[24:27], s3 offen lds
    s_lshl_b32 s3, s86, 11
    s_sub_u32 s45, s45, s3
    s_mul_i32 s3, s86, 14336
    s_sub_u32 s44, s44, s3
    s_add_u32 m0, s45, 77824
    s_add_u32 s3, s44, 200704
    buffer_load_dwordx4 v3, s[24:27], s3 offen lds
    s_lshl3_add_u32 s3, s42, s10
    s_lshl_b32 s3, s3, 3
    v_lshrrev_b32 v10, 3, v1
    v_add_u32 v10, s3, v10
    v_mul_u32_u24 v61, 896, v10
    v_and_b32 v10, 7, v1
    v_lshl_add_u32 v61, v10, 4, v61
    s_lshl_b32 s3, s43, 7
    v_add_u32 v61, s3, v61
    global_load_dwordx4 v[56:59], v61, s[4:5]
    v_lshrrev_b32 v5, 5, v1
    v_bfe_u32 v12, v1, 2, 2
    v_lshl_add_u32 v5, v5, 2, v12
    v_lshlrev_b32 v5, 7, v5
    v_bfe_u32 v12, v1, 3, 1
    v_lshl_add_u32 v5, v12, 6, v5
    v_bfe_u32 v12, v1, 4, 1
    v_lshl_add_u32 v5, v12, 5, v5
    v_and_b32 v12, 3, v1
    v_lshl_add_u32 v5, v12, 3, v5
    s_mul_i32 s3, s86, 49152
    s_add_u32 s3, s3, 49152
    v_add_u32 v5, s3, v5
    v_xor_b32 v6, 64, v5
    v_and_b32 v4, 7, v1
    v_lshlrev_b32 v4, 7, v4
    s_lshl1_add_u32 s49, s88, s86
    s_lshl_b32 s50, s49, 10
    s_add_u32 s50, s50, 16777216
    s_waitcnt vmcnt(1)
    s_mov_b64 exec, 1
    v_mov_b32 v11, 1
    ds_add_u32 v7, v11 offset:16
    s_mov_b64 exec, -1
    s_mov_b32 s47, 0
L_sp_43:
    ds_read_b32 v11, v7 offset:16
    s_add_u32 s47, s47, 1
    s_waitcnt lgkmcnt(0)
    v_cmp_gt_u32 vcc, 16, v11
    s_nop 0
    s_cbranch_vccz L_spe_44
    s_cmp_lt_u32 s47, 1600000
    s_cbranch_scc1 L_sp_43
L_spe_44:
    ds_read_b64_tr_b16 v[128:129], v5 offset:0
    ds_read_b64_tr_b16 v[130:131], v5 offset:1024
    ds_read_b64_tr_b16 v[132:133], v6 offset:0
    ds_read_b64_tr_b16 v[134:135], v6 offset:1024
    ds_read_b64_tr_b16 v[136:137], v5 offset:2048
    ds_read_b64_tr_b16 v[138:139], v5 offset:3072
    ds_read_b64_tr_b16 v[140:141], v6 offset:2048
    ds_read_b64_tr_b16 v[142:143], v6 offset:3072
    ds_read_b64_tr_b16 v[144:145], v5 offset:3584
    ds_read_b64_tr_b16 v[146:147], v5 offset:4608
    ds_read_b64_tr_b16 v[148:149], v6 offset:3584
    ds_read_b64_tr_b16 v[150:151], v6 offset:4608
    ds_read_b64_tr_b16 v[152:153], v5 offset:5632
    ds_read_b64_tr_b16 v[154:155], v5 offset:6656
    ds_read_b64_tr_b16 v[156:157], v6 offset:5632
    ds_read_b64_tr_b16 v[158:159], v6 offset:6656
    ds_read_b64_tr_b16 v[160:161], v5 offset:7168
    ds_read_b64_tr_b16 v[162:163], v5 offset:8192
    ds_read_b64_tr_b16 v[164:165], v6 offset:7168
    ds_read_b64_tr_b16 v[166:167], v6 offset:8192
    ds_read_b64_tr_b16 v[168:169], v5 offset:9216
    ds_read_b64_tr_b16 v[170:171], v5 offset:10240
    ds_read_b64_tr_b16 v[172:173], v6 offset:9216
    ds_read_b64_tr_b16 v[174:175], v6 offset:10240
    ds_read_b64_tr_b16 v[176:177], v5 offset:10752
    ds_read_b64_tr_b16 v[178:179], v5 offset:11776
    ds_read_b64_tr_b16 v[180:181], v6 offset:10752
    ds_read_b64_tr_b16 v[182:183], v6 offset:11776
    ds_read_b64_tr_b16 v[184:185], v5 offset:12800
    ds_read_b64_tr_b16 v[186:187], v5 offset:13824
    ds_read_b64_tr_b16 v[188:189], v6 offset:12800
    ds_read_b64_tr_b16 v[190:191], v6 offset:13824
    ds_read_b64_tr_b16 v[192:193], v5 offset:14336
    ds_read_b64_tr_b16 v[194:195], v5 offset:15360
    ds_read_b64_tr_b16 v[196:197], v6 offset:14336
    ds_read_b64_tr_b16 v[198:199], v6 offset:15360
    ds_read_b64_tr_b16 v[200:201], v5 offset:16384
    ds_read_b64_tr_b16 v[202:203], v5 offset:17408
    ds_read_b64_tr_b16 v[204:205], v6 offset:16384
    ds_read_b64_tr_b16 v[206:207], v6 offset:17408
    ds_read_b64_tr_b16 v[208:209], v5 offset:17920
    ds_read_b64_tr_b16 v[210:211], v5 offset:18944
    ds_read_b64_tr_b16 v[212:213], v6 offset:17920
    ds_read_b64_tr_b16 v[214:215], v6 offset:18944
    ds_read_b64_tr_b16 v[216:217], v5 offset:19968
    ds_read_b64_tr_b16 v[218:219], v5 offset:20992
    ds_read_b64_tr_b16 v[220:221], v6 offset:19968
    ds_read_b64_tr_b16 v[222:223], v6 offset:20992
    ds_read_b64_tr_b16 v[224:225], v5 offset:21504
    ds_read_b64_tr_b16 v[226:227], v5 offset:22528
    ds_read_b64_tr_b16 v[228:229], v6 offset:21504
    ds_read_b64_tr_b16 v[230:231], v6 offset:22528
    ds_read_b64_tr_b16 v[232:233], v5 offset:23552
    ds_read_b64_tr_b16 v[234:235], v5 offset:24576
    ds_read_b64_tr_b16 v[236:237], v6 offset:23552
    ds_read_b64_tr_b16 v[238:239], v6 offset:24576
    ds_read_b64_tr_b16 v[240:241], v5 offset:25088
    ds_read_b64_tr_b16 v[242:243], v5 offset:26112
    ds_read_b64_tr_b16 v[244:245], v6 offset:25088
    ds_read_b64_tr_b16 v[246:247], v6 offset:26112
    ds_read_b64_tr_b16 v[248:249], v5 offset:27136
    ds_read_b64_tr_b16 v[250:251], v5 offset:28160
    ds_read_b64_tr_b16 v[252:253], v6 offset:27136
    ds_read_b64_tr_b16 v[254:255], v6 offset:28160
    s_waitcnt lgkmcnt(0)
    s_mov_b64 exec, 1
    v_mov_b32 v11, 1
    ds_add_u32 v7, v11 offset:16
    s_mov_b64 exec, -1
    v_lshrrev_b32 v10, 5, v1
    v_and_b32 v11, 7, v1
    v_xor_b32 v10, v10, v11
    v_lshlrev_b32 v48, 8, v11
    v_lshl_add_u32 v48, v10, 4, v48
    v_bfe_u32 v10, v1, 3, 2
    v_lshl_add_u32 v48, v10, 11, v48
    s_lshl_b32 s3, s86, 14
    s_lshl_b32 s44, s87, 13
    s_add_u32 s3, s3, s44
    s_add_u32 s3, s3, 49152
    v_add_u32 v48, s3, v48
    v_xor_b32 v49, 32, v48
    v_xor_b32 v50, 64, v48
    v_xor_b32 v51, 96, v48
    s_mov_b32 s47, 0
L_sp_45:
    ds_read_b32 v11, v7 offset:16
    s_add_u32 s47, s47, 1
    s_waitcnt lgkmcnt(0)
    v_cmp_gt_u32 vcc, 20, v11
    s_nop 0
    s_cbranch_vccz L_spe_46
    s_cmp_lt_u32 s47, 1600000
    s_cbranch_scc1 L_sp_45
L_spe_46:
    s_mov_b32 s47, 0
L_sp_47:
    ds_read_b32 v11, v7 offset:0
    s_add_u32 s47, s47, 1
    s_waitcnt lgkmcnt(0)
    v_cmp_gt_u32 vcc, 4, v11
    s_nop 0
    s_cbranch_vccz L_spe_48
    s_sleep 2
    s_cmp_lt_u32 s47, 1600000
    s_cbranch_scc1 L_sp_47
L_spe_48:
    buffer_load_dwordx2 v[12:13], v4, s[20:23], s50 offen sc1
    s_waitcnt vmcnt(0)
    v_cmp_ne_u64 vcc, s[80:81], v[12:13]
    s_nop 0
    s_cbranch_vccz L_ook
    s_mov_b64 exec, 255
    s_mov_b32 s47, 0
L_poll_49:
    buffer_load_dwordx2 v[12:13], v4, s[20:23], s50 offen offset:0 sc1
    s_add_u32 s47, s47, 1
    s_waitcnt vmcnt(0)
    v_cmp_ne_u64 vcc, s[80:81], v[12:13]
    s_nop 0
    s_cbranch_vccz L_polle_50
    s_sleep 4
    s_cmp_lt_u32 s47, 200000
    s_cbranch_scc1 L_poll_49
L_polle_50:
    s_mov_b64 exec, -1
L_ook:
    s_setprio 2
    s_lshl_b32 s3, s49, 14
    s_add_u32 s3, s3, 14680064
    buffer_load_dwordx4 v[64:67], v2, s[20:23], s3 offen offset:0 sc1
    buffer_load_dwordx4 v[68:71], v2, s[20:23], s3 offen offset:1024 sc1
    buffer_load_dwordx4 v[72:75], v2, s[20:23], s3 offen offset:2048 sc1
    buffer_load_dwordx4 v[76:79], v2, s[20:23], s3 offen offset:3072 sc1
    s_add_u32 s3, s3, 4096
    buffer_load_dwordx4 v[80:83], v2, s[20:23], s3 offen offset:0 sc1
    buffer_load_dwordx4 v[84:87], v2, s[20:23], s3 offen offset:1024 sc1
    buffer_load_dwordx4 v[88:91], v2, s[20:23], s3 offen offset:2048 sc1
    buffer_load_dwordx4 v[92:95], v2, s[20:23], s3 offen offset:3072 sc1
    s_add_u32 s3, s3, 4096
    buffer_load_dwordx4 v[96:99], v2, s[20:23], s3 offen offset:0 sc1
    buffer_load_dwordx4 v[100:103], v2, s[20:23], s3 offen offset:1024 sc1
    buffer_load_dwordx4 v[104:107], v2, s[20:23], s3 offen offset:2048 sc1
    buffer_load_dwordx4 v[108:111], v2, s[20:23], s3 offen offset:3072 sc1
    s_add_u32 s3, s3, 4096
    buffer_load_dwordx4 v[112:115], v2, s[20:23], s3 offen offset:0 sc1
    buffer_load_dwordx4 v[116:119], v2, s[20:23], s3 offen offset:1024 sc1
    buffer_load_dwordx4 v[120:123], v2, s[20:23], s3 offen offset:2048 sc1
    buffer_load_dwordx4 v[124:127], v2, s[20:23], s3 offen offset:3072 sc1
    s_add_u32 s3, s3, 4096
    s_setprio 0
    s_waitcnt vmcnt(15)
    v_mfma_f32_32x32x16_bf16 v[16:31], v[128:131], v[64:67], 0
    v_mfma_f32_32x32x16_bf16 v[32:47], v[132:135], v[64:67], 0
    s_waitcnt vmcnt(14)
    v_mfma_f32_32x32x16_bf16 v[16:31], v[136:139], v[68:71], v[16:31]
    v_mfma_f32_32x32x16_bf16 v[32:47], v[140:143], v[68:71], v[32:47]
    s_waitcnt vmcnt(13)
    v_mfma_f32_32x32x16_bf16 v[16:31], v[144:147], v[72:75], v[16:31]
    v_mfma_f32_32x32x16_bf16 v[32:47], v[148:151], v[72:75], v[32:47]
    s_waitcnt vmcnt(12)
    v_mfma_f32_32x32x16_bf16 v[16:31], v[152:155], v[76:79], v[16:31]
    v_mfma_f32_32x32x16_bf16 v[32:47], v[156:159], v[76:79], v[32:47]
    s_waitcnt vmcnt(11)
    v_mfma_f32_32x32x16_bf16 v[16:31], v[160:163], v[80:83], v[16:31]
    v_mfma_f32_32x32x16_bf16 v[32:47], v[164:167], v[80:83], v[32:47]
    s_waitcnt vmcnt(10)
    v_mfma_f32_32x32x16_bf16 v[16:31], v[168:171], v[84:87], v[16:31]
    v_mfma_f32_32x32x16_bf16 v[32:47], v[172:175], v[84:87], v[32:47]
    s_waitcnt vmcnt(9)
    v_mfma_f32_32x32x16_bf16 v[16:31], v[176:179], v[88:91], v[16:31]
    v_mfma_f32_32x32x16_bf16 v[32:47], v[180:183], v[88:91], v[32:47]
    s_waitcnt vmcnt(8)
    v_mfma_f32_32x32x16_bf16 v[16:31], v[184:187], v[92:95], v[16:31]
    v_mfma_f32_32x32x16_bf16 v[32:47], v[188:191], v[92:95], v[32:47]
    s_waitcnt vmcnt(7)
    v_mfma_f32_32x32x16_bf16 v[16:31], v[192:195], v[96:99], v[16:31]
    v_mfma_f32_32x32x16_bf16 v[32:47], v[196:199], v[96:99], v[32:47]
    s_waitcnt vmcnt(6)
    v_mfma_f32_32x32x16_bf16 v[16:31], v[200:203], v[100:103], v[16:31]
    v_mfma_f32_32x32x16_bf16 v[32:47], v[204:207], v[100:103], v[32:47]
    s_waitcnt vmcnt(5)
    v_mfma_f32_32x32x16_bf16 v[16:31], v[208:211], v[104:107], v[16:31]
    v_mfma_f32_32x32x16_bf16 v[32:47], v[212:215], v[104:107], v[32:47]
    s_waitcnt vmcnt(4)
    v_mfma_f32_32x32x16_bf16 v[16:31], v[216:219], v[108:111], v[16:31]
    v_mfma_f32_32x32x16_bf16 v[32:47], v[220:223], v[108:111], v[32:47]
    s_waitcnt vmcnt(3)
    v_mfma_f32_32x32x16_bf16 v[16:31], v[224:227], v[112:115], v[16:31]
    v_mfma_f32_32x32x16_bf16 v[32:47], v[228:231], v[112:115], v[32:47]
    s_waitcnt vmcnt(2)
    v_mfma_f32_32x32x16_bf16 v[16:31], v[232:235], v[116:119], v[16:31]
    v_mfma_f32_32x32x16_bf16 v[32:47], v[236:239], v[116:119], v[32:47]
    s_waitcnt vmcnt(1)
    v_mfma_f32_32x32x16_bf16 v[16:31], v[240:243], v[120:123], v[16:31]
    v_mfma_f32_32x32x16_bf16 v[32:47], v[244:247], v[120:123], v[32:47]
    s_waitcnt vmcnt(0)
    v_mfma_f32_32x32x16_bf16 v[16:31], v[248:251], v[124:127], v[16:31]
    v_mfma_f32_32x32x16_bf16 v[32:47], v[252:255], v[124:127], v[32:47]
    s_nop 10
    ds_write_b128 v48, v[16:19] offset:0
    ds_write_b128 v49, v[20:23] offset:0
    ds_write_b128 v50, v[24:27] offset:0
    ds_write_b128 v51, v[28:31] offset:0
    ds_write_b128 v48, v[32:35] offset:128
    ds_write_b128 v49, v[36:39] offset:128
    ds_write_b128 v50, v[40:43] offset:128
    ds_write_b128 v51, v[44:47] offset:128
    s_mov_b32 s32, s16
    s_and_b32 s33, s17, 0xffff
    s_mov_b32 s34, 1835008
    s_mov_b32 s35, 0x20000
    v_lshrrev_b32 v10, 3, v1
    v_and_b32 v11, 7, v1
    v_lshlrev_b32 v11, 1, v11
    v_xor_b32 v11, v11, v10
    v_lshlrev_b32 v10, 8, v10
    v_lshl_add_u32 v10, v11, 4, v10
    s_lshl_b32 s3, s10, 13
    s_cmp_eq_u32 s10, 6
    s_cselect_b32 s3, 90112, s3
    s_cmp_eq_u32 s10, 7
    s_cselect_b32 s3, 137216, s3
    v_add_u32 v12, s3, v10
    v_xor_b32 v13, 16, v12
    s_lshl_b32 s3, s10, 11
    s_add_u32 s3, s3, 49152
    v_add_u32 v14, s3, v10
    v_xor_b32 v15, 16, v14
    s_mov_b32 s52, 0xbfb8aa3b
    s_mov_b32 s53, s52
    v_lshlrev_b32 v200, 16, v56
    v_and_b32 v201, 0xffff0000, v56
    v_lshlrev_b32 v202, 16, v57
    v_and_b32 v203, 0xffff0000, v57
    v_lshlrev_b32 v204, 16, v58
    v_and_b32 v205, 0xffff0000, v58
    v_lshlrev_b32 v206, 16, v59
    v_and_b32 v207, 0xffff0000, v59
    s_waitcnt lgkmcnt(0)
    s_barrier
    ds_read_b128 v[144:147], v12 offset:0
    ds_read_b128 v[148:151], v13 offset:0
    ds_read_b128 v[152:155], v12 offset:2048
    ds_read_b128 v[156:159], v13 offset:2048
    ds_read_b128 v[160:163], v12 offset:4096
    ds_read_b128 v[164:167], v13 offset:4096
    ds_read_b128 v[168:171], v12 offset:6144
    ds_read_b128 v[172:175], v13 offset:6144
    ds_read_b128 v[176:179], v14 offset:0
    ds_read_b128 v[180:183], v15 offset:0
    ds_read_b128 v[184:187], v14 offset:16384
    ds_read_b128 v[188:191], v15 offset:16384
    s_waitcnt lgkmcnt(8)
    v_pk_add_f32 v[144:145], v[144:145], v[152:153]
    v_pk_add_f32 v[146:147], v[146:147], v[154:155]
    v_pk_add_f32 v[148:149], v[148:149], v[156:157]
    v_pk_add_f32 v[150:151], v[150:151], v[158:159]
    s_waitcnt lgkmcnt(4)
    v_pk_add_f32 v[160:161], v[160:161], v[168:169]
    v_pk_add_f32 v[162:163], v[162:163], v[170:171]
    v_pk_add_f32 v[164:165], v[164:165], v[172:173]
    v_pk_add_f32 v[166:167], v[166:167], v[174:175]
    v_pk_add_f32 v[144:145], v[144:145], v[160:161]
    v_pk_add_f32 v[146:147], v[146:147], v[162:163]
    v_pk_add_f32 v[148:149], v[148:149], v[164:165]
    v_pk_add_f32 v[150:151], v[150:151], v[166:167]
    v_pk_mul_f32 v[192:193], v[144:145], s[52:53]
    v_pk_mul_f32 v[194:195], v[146:147], s[52:53]
    v_pk_mul_f32 v[196:197], v[148:149], s[52:53]
    v_pk_mul_f32 v[198:199], v[150:151], s[52:53]
    v_exp_f32 v192, v192
    v_exp_f32 v193, v193
    v_exp_f32 v194, v194
    v_exp_f32 v195, v195
    v_exp_f32 v196, v196
    v_exp_f32 v197, v197
    v_exp_f32 v198, v198
    v_exp_f32 v199, v199
    s_waitcnt lgkmcnt(0)
    v_pk_add_f32 v[176:177], v[176:177], v[184:185]
    v_pk_add_f32 v[178:179], v[178:179], v[186:187]
    v_pk_add_f32 v[180:181], v[180:181], v[188:189]
    v_pk_add_f32 v[182:183], v[182:183], v[190:191]
    v_pk_add_f32 v[192:193], v[192:193], 1.0 op_sel_hi:[1,0]
    v_pk_add_f32 v[194:195], v[194:195], 1.0 op_sel_hi:[1,0]
    v_pk_add_f32 v[196:197], v[196:197], 1.0 op_sel_hi:[1,0]
    v_pk_add_f32 v[198:199], v[198:199], 1.0 op_sel_hi:[1,0]
    v_rcp_f32 v192, v192
    v_rcp_f32 v193, v193
    v_rcp_f32 v194, v194
    v_rcp_f32 v195, v195
    v_rcp_f32 v196, v196
    v_rcp_f32 v197, v197
    v_rcp_f32 v198, v198
    v_rcp_f32 v199, v199
    v_pk_mul_f32 v[176:177], v[176:177], v[144:145]
    v_pk_mul_f32 v[178:179], v[178:179], v[146:147]
    v_pk_mul_f32 v[180:181], v[180:181], v[148:149]
    v_pk_mul_f32 v[182:183], v[182:183], v[150:151]
    v_pk_fma_f32 v[144:145], v[176:177], v[192:193], v[200:201]
    v_pk_fma_f32 v[146:147], v[178:179], v[194:195], v[202:203]
    v_pk_fma_f32 v[148:149], v[180:181], v[196:197], v[204:205]
    v_pk_fma_f32 v[150:151], v[182:183], v[198:199], v[206:207]
    v_cvt_pk_bf16_f32 v56, v144, v145
    v_cvt_pk_bf16_f32 v57, v146, v147
    v_cvt_pk_bf16_f32 v58, v148, v149
    v_cvt_pk_bf16_f32 v59, v150, v151
    buffer_store_dwordx4 v[56:59], v61, s[32:35], 0 offen sc1
L_end:
    s_endpgm
.section .rodata,"a"
.p2align 6
.amdhsa_kernel recurrent_scan__sliding_block__dense_activation_silu__prompt_kernel
  .amdhsa_next_free_vgpr 256
  .amdhsa_next_free_sgpr 102
  .amdhsa_accum_offset 256
  .amdhsa_group_segment_fixed_size 0
  .amdhsa_kernarg_size 72
  .amdhsa_user_sgpr_count 2
  .amdhsa_user_sgpr_kernarg_segment_ptr 1
  .amdhsa_system_sgpr_workgroup_id_x 1
.end_amdhsa_kernel
```
